```python
import torch

def _softmax(x, axis=-1):
    return torch.softmax(x, dim=axis)
def _gelu(x):
    return torch.nn.functional.gelu(x, approximate="tanh")
def _silu(x):
    return torch.nn.functional.silu(x)
def _sigmoid(x):
    return torch.sigmoid(x)
def _layernorm(x, axis=-1, eps=1e-5):
    m = x.mean(dim=axis, keepdim=True)
    v = x.var(dim=axis, keepdim=True, unbiased=False)
    return (x - m) / torch.sqrt(v + eps)
def _scatter_add(tgt, idx, src, axis=0):
    return tgt.clone().index_add_(axis, idx, src)
def _segment_sum(src, seg, n):
    out = torch.zeros((n,) + src.shape[1:], dtype=src.dtype)
    return out.index_add_(0, seg, src)
def _pad(x, pw):
    flat = tuple(v for pair in reversed(pw) for v in pair)
    return torch.nn.functional.pad(x, flat)

kernel_name = 'sequential_preLN__ssm_conv_s4d__dense_activation_relu__prompt'

def setup_inputs():

    _w = (lambda a: (lambda t: t.to(torch.bfloat16) if t.is_floating_point() else t)(torch.as_tensor(a)))
    def _A_setup():
        Bsz, L, D, N = 1, 2048, 512, 128
        return {
            "u": _w((lambda *s: torch.randn(*s, dtype=torch.bfloat16) * 0.05)(Bsz, L, D)),
            "log_A_real": _w((lambda *s: torch.randn(*s, dtype=torch.bfloat16) * 6.4)(D, N) * 0.5),
            "A_imag": _w((lambda *s: torch.randn(*s, dtype=torch.bfloat16) * 0.05)(D, N) * 3.14),
            "C_real": _w((lambda *s: torch.randn(*s, dtype=torch.bfloat16) * 0.05)(D, N) / N ** 0.5),
            "C_imag": _w((lambda *s: torch.randn(*s, dtype=torch.bfloat16) * 0.05)(D, N) / N ** 0.5),
            "log_dt": _w((lambda *s: torch.randn(*s, dtype=torch.bfloat16) * 0.05)(D) * 0.5 - 4.0),
            "D_skip": _w((lambda *s: torch.randn(*s, dtype=torch.bfloat16) * 0.05)(D)),
        }
    _A_in = _A_setup()

    def _B_setup():
        B, S, D, Dff = 1, 2048, 512, 1792
        return {
            "x": _w((lambda *s: torch.randn(*s, dtype=torch.bfloat16) * 0.05)(B, S, D)),
            "w1": _w((lambda *s: torch.randn(*s, dtype=torch.bfloat16) * 0.05)(D, Dff)),
            "w2": _w((lambda *s: torch.randn(*s, dtype=torch.bfloat16) * 0.05)(Dff, D)),
        }
    _B_in = _B_setup()

    return {
        "A_u": _A_in["u"],
        "A_log_A_real": _A_in["log_A_real"],
        "A_A_imag": _A_in["A_imag"],
        "A_C_real": _A_in["C_real"],
        "A_C_imag": _A_in["C_imag"],
        "A_log_dt": _A_in["log_dt"],
        "A_D_skip": _A_in["D_skip"],
        "B_x": _B_in["x"],
        "B_w1": _B_in["w1"],
        "B_w2": _B_in["w2"],
    }

def reference(A_u, A_log_A_real, A_A_imag, A_C_real, A_C_imag, A_log_dt, A_D_skip, B_x, B_w1, B_w2):
    def _A_ref(u, log_A_real, A_imag, C_real, C_imag, log_dt, D_skip):
        L = u.shape[1]
        dt = torch.exp(log_dt)
        A = -torch.exp(log_A_real) + 1j * A_imag
        C = (C_real + 1j * C_imag) * dt[:, None]
        pos = (lambda x, dt: x.to(dt))(torch.arange(L), log_dt.dtype)
        P = torch.exp((A * dt[:, None])[:, :, None] * pos[None, None, :])
        K = 2.0 * torch.einsum("dn,dnl->dl", C, P).real
        L2 = 2 * L
        u_t = (lambda x, *d: x.permute(*d))(u, 0, 2, 1)
        Kf = (lambda x, *a, **k: torch.fft.rfft(x.float(), *a, **k))(K, L2)
        Uf = (lambda x, *a, **k: torch.fft.rfft(x.float(), *a, **k))(u_t, L2)
        y = (lambda x, *a, **k: torch.fft.irfft(x, *a, **k).to(torch.bfloat16))(Uf * Kf[None, :, :], L2)[:, :, :L]
        y = (lambda x, *d: x.permute(*d))(y, 0, 2, 1)
        return y + u * D_skip[None, None, :]

    def _B_ref(x, w1, w2):
        h = torch.einsum("bsd,df->bsf", x, w1)
        zero = torch.zeros_like(h)
        h = torch.maximum(h, zero)
        return torch.einsum("bsf,fd->bsd", h, w2)

    x = A_u
    h = x + _A_ref(_layernorm(x, axis=-1), A_log_A_real, A_A_imag, A_C_real, A_C_imag, A_log_dt, A_D_skip)
    h2 = h + _B_ref(_layernorm(h, axis=-1), B_w1, B_w2)
    return h2
```

```asm
; @launch grid=(256,1,1) block=(512,1,1) lds=163840
.amdgcn_target "amdgcn-amd-amdhsa--gfx950"
.text
.globl sequential_preLN__ssm_conv_s4d__dense_activation_relu__prompt_kernel
.p2align 8
.type sequential_preLN__ssm_conv_s4d__dense_activation_relu__prompt_kernel,@function
sequential_preLN__ssm_conv_s4d__dense_activation_relu__prompt_kernel:
    s_load_dwordx16 s[16:31], s[0:1], 0
    s_load_dwordx8 s[32:39], s[0:1], 64
    s_load_dwordx2 s[40:41], s[0:1], 96
    s_cmp_ge_u32 s2, 256
    s_cbranch_scc1 K2_END
    s_getpc_b64 s[58:59]
P1_PC:
    s_sub_u32 s58, s58, P1_PC-sequential_preLN__ssm_conv_s4d__dense_activation_relu__prompt_kernel
    s_subb_u32 s59, s59, 0
    s_lshr_b32 s4, s2, 3
    s_lshl_b32 s4, s4, 10
    v_lshlrev_b32 v135, 7, v0
    v_add_u32 v135, s4, v135
    v_min_u32 v135, CODE_END-sequential_preLN__ssm_conv_s4d__dense_activation_relu__prompt_kernel-4, v135
    v_cmp_gt_u32 vcc, 8, v0
    s_cbranch_vccz P1_NOPC
    s_mov_b64 exec, vcc
    global_load_dword v250, v135, s[58:59]
    s_mov_b64 exec, -1
P1_NOPC:
    v_lshrrev_b32 v2, 6, v0
    v_and_b32 v1, 63, v0
    s_and_b32 s3, s2, 7
    v_readfirstlane_b32 s5, v2
    s_lshl_b32 s3, s3, 5
    s_lshr_b32 s4, s2, 3
    s_add_u32 s45, s4, s3
    s_bfe_u32 s6, s5, 0x10001
    s_and_b32 s7, s5, 1
    s_lshl_b32 s3, s45, 1
    s_add_u32 s3, s3, s6
    s_lshl_b32 s42, s3, 8
    s_lshl_b32 s44, s7, 7
    v_lshlrev_b32 v3, 1, v1
    v_add_u32 v3, s44, v3
    s_lshl_b32 s69, s45, 2
    s_lshl_b32 s68, s5, 2
    v_lshlrev_b32 v130, 10, v1
    v_lshlrev_b32 v131, 4, v1
    s_cmp_lt_u32 s5, 4
    s_cbranch_scc0 P1_XL
    v_lshrrev_b32 v128, 3, v1
    v_and_b32 v129, 6, v128
    v_and_b32 v130, 7, v1
    v_xor_b32 v130, v130, v129
    v_lshlrev_b32 v130, 4, v130
    v_lshl_add_u32 v130, v128, 10, v130
    s_lshl_b32 s70, s4, 2
    s_add_u32 s70, s70, s5
    s_sub_u32 s49, s70, 0
    s_lshl_b32 s70, s49, 14
    s_and_b32 s71, s69, 0x380
    s_add_u32 s70, s70, s71
    s_lshl_b32 s71, s5, 11
    s_add_u32 s71, s71, 99328
    s_mov_b32 m0, s71
    s_lshl_b32 s68, s49, 7
    s_lshl_b32 s43, s45, 13
    s_lshl_b32 s44, s5, 11
    s_add_u32 s43, s43, s44
    v_lshrrev_b32 v132, 5, v1
    v_and_b32 v133, 31, v1
    v_lshlrev_b32 v132, 17, v132
    v_lshl_add_u32 v132, v133, 4, v132
    v_mov_b32 v176, -1
    v_mov_b32 v177, -1
    v_mov_b32 v178, -1
    v_mov_b32 v179, -1
    v_mov_b32 v180, 0
    v_mov_b32 v181, 0
    v_mov_b32 v182, 0
    v_mov_b32 v183, 0
    s_lshl_b32 s84, s45, 9
    s_lshl_b32 s85, s5, 19
    s_add_u32 s84, s84, s85
    s_add_u32 s84, s84, 0x200000
    s_add_u32 s85, s84, 262144
    s_lshl_b32 s86, s45, 2
    s_add_u32 s86, s86, s5
    s_lshl_b32 s86, s86, 7
    s_add_u32 s86, s86, 0x560000
    s_mov_b32 s44, 0x540000
    s_waitcnt lgkmcnt(0)
    s_mov_b32 s80, s16
    s_mov_b32 s81, s17
    s_mov_b32 s82, 0x200000
    s_mov_b32 s83, 0x00020000
    buffer_load_dwordx4 v[136:139], v131, s[80:83], s43 offen
    buffer_load_dwordx4 v[140:143], v131, s[80:83], s43 offen offset:1024
    s_load_dword s46, s[26:27], s69
    s_load_dword s66, s[28:29], s69
    s_load_dwordx2 s[100:101], s[40:41], s44
    s_mov_b32 s8, s18
    s_mov_b32 s9, s19
    s_mov_b32 s10, 0x20000
    s_mov_b32 s11, 0x00020000
    s_mov_b32 s48, s20
    s_mov_b32 s49, s21
    s_mov_b32 s50, 0x20000
    s_mov_b32 s51, 0x00020000
    buffer_load_ushort v8, v3, s[8:11], s42 offen
    buffer_load_ushort v9, v3, s[48:51], s42 offen
    v_and_b32 v128, 7, v1
    v_lshrrev_b32 v129, 3, v1
    v_mul_u32_u24 v127, 16512, v129
    v_lshl_add_u32 v127, v128, 4, v127
    v_and_b32 v126, 3, v1
    v_lshl_add_u32 v126, v126, 3, v129
    v_lshl_add_u32 v126, v128, 6, v126
    v_lshl_add_u32 v126, v126, 2, s71
    v_xor_b32 v128, 32, v126
    v_xor_b32 v114, 64, v126
    v_xor_b32 v115, 96, v126
    s_and_b32 s49, s45, 0xe0
    s_mul_i32 s49, s49, 16512
    s_add_u32 s49, s49, s68
    s_add_u32 s68, s49, 0x1000000
    s_mov_b32 s12, s40
    s_mov_b32 s13, s41
    s_mov_b32 s14, 0x10000000
    s_mov_b32 s15, 0x00020000
    s_mov_b32 s72, s32
    s_mov_b32 s73, s33
    s_mov_b32 s74, 0x1c0000
    s_mov_b32 s75, 0x00020000
    s_mov_b32 s76, s34
    s_mov_b32 s77, s35
    s_mov_b32 s78, 0x1c0000
    s_mov_b32 s79, 0x00020000
    s_branch P1_COM
P1_XL:
    v_xor_b32 v4, 128, v3
    s_mov_b32 s44, 0x540000
    s_waitcnt lgkmcnt(0)
    s_load_dword s46, s[26:27], s69
    s_load_dword s66, s[28:29], s69
    s_load_dwordx2 s[100:101], s[40:41], s44
    s_mov_b32 s8, s18
    s_mov_b32 s9, s19
    s_mov_b32 s10, 0x20000
    s_mov_b32 s11, 0x00020000
    s_mov_b32 s48, s20
    s_mov_b32 s49, s21
    s_mov_b32 s50, 0x20000
    s_mov_b32 s51, 0x00020000
    buffer_load_ushort v8, v3, s[8:11], s42 offen
    buffer_load_ushort v9, v3, s[48:51], s42 offen
    s_mov_b32 s52, s22
    s_mov_b32 s53, s23
    s_mov_b32 s54, 0x20000
    s_mov_b32 s55, 0x00020000
    s_mov_b32 s56, s24
    s_mov_b32 s57, s25
    s_mov_b32 s58, 0x20000
    s_mov_b32 s59, 0x00020000
    buffer_load_ushort v10, v3, s[52:55], s42 offen
    buffer_load_ushort v11, v3, s[56:59], s42 offen
    buffer_load_ushort v12, v4, s[52:55], s42 offen
    buffer_load_ushort v13, v4, s[56:59], s42 offen
    v_mov_b32 v127, 0
    s_and_b32 s84, s2, 7
    s_mul_i32 s84, s84, 28
    s_add_u32 s84, s84, s4
    s_and_b32 s85, s84, 7
    s_mul_i32 s86, s85, 7168
    s_mul_i32 s85, s85, 229376
    s_lshr_b32 s84, s84, 3
    s_lshl_b32 s84, s84, 2
    s_add_u32 s84, s84, s5
    s_sub_u32 s84, s84, 4
    s_lshl_b32 s87, s84, 6
    s_add_u32 s86, s86, s87
    s_add_u32 s86, s86, 0x550000
    s_lshl_b32 s84, s84, 5
    s_add_u32 s84, s84, s85
    v_lshrrev_b32 v132, 1, v1
    v_mul_u32_u24 v132, 3584, v132
    v_and_b32 v133, 1, v1
    v_lshl_add_u32 v132, v133, 4, v132
    s_cmp_lt_u32 s4, 28
    s_cselect_b32 s84, s84, 0
    s_add_u32 s85, s84, 114688
    v_lshlrev_b32 v133, 7, v1
    s_lshl_b32 s87, s2, 2
    s_add_u32 s87, s87, s5
    s_sub_u32 s87, s87, 4
    s_mul_i32 s87, s87, 1792
    s_mov_b32 s72, s32
    s_mov_b32 s73, s33
    s_mov_b32 s74, 0x1c0000
    s_mov_b32 s75, 0x00020000
    s_mov_b32 s76, s34
    s_mov_b32 s77, s35
    s_mov_b32 s78, 0x1c0000
    s_mov_b32 s79, 0x00020000
    s_mov_b32 s12, s40
    s_mov_b32 s13, s41
    s_mov_b32 s14, 0x10000000
    s_mov_b32 s15, 0x00020000
P1_COM:
    v_mov_b32 v235, 0
    v_mov_b32 v236, 0
    v_mov_b32 v237, 0
    v_mov_b32 v238, 0
    v_mov_b32 v239, 0
    v_mov_b32 v240, 0
    s_mov_b32 s60, 0x3fb8aa3b
    s_mov_b32 s61, 0x32a57060
    s_mov_b32 s62, 0x3f317218
    s_mul_i32 s67, s6, 49664
    s_add_u32 s63, s67, 13312
    v_lshlrev_b32 v5, 1, v3
    v_add_u32 v5, s63, v5
    v_and_b32 v6, 15, v1
    v_mul_u32_u24 v6, 544, v6
    v_lshrrev_b32 v7, 4, v1
    v_lshl_add_u32 v6, v7, 4, v6
    s_lshr_b32 s64, s5, 2
    s_mul_i32 s65, s64, 8704
    s_add_u32 s65, s65, s63
    v_add_u32 v18, s65, v6
    s_mul_i32 s65, s7, 8704
    s_add_u32 s65, s65, s63
    s_add_u32 s65, s65, 13056
    v_add_u32 v19, s65, v6
    v_mov_b32 v184, 0
    v_mov_b32 v185, 0
    v_mov_b32 v186, 0
    v_mov_b32 v187, 0
    s_lshl_b32 s65, s64, 1
    s_add_u32 s65, s65, s7
    s_mul_i32 s65, s65, 2304
    s_add_u32 s65, s65, s67
    v_add_u32 v188, s65, v131
    ds_write_b128 v188, v[184:187] offset:4096
    ds_write_b128 v188, v[184:187] offset:5120
    s_mov_b64 exec, 0xffff
    ds_write_b128 v188, v[184:187] offset:6144
    s_mov_b64 exec, -1
    s_waitcnt lgkmcnt(0)
    s_add_u32 s100, s100, 1
    s_addc_u32 s101, s101, 0
    s_bitset1_b32 s100, 31
    s_lshl_b32 s47, s46, 16
    s_and_b32 s46, s46, 0xffff0000
    s_cmp_eq_u32 s6, 0
    s_cselect_b32 s46, s47, s46
    v_mov_b32 v14, s46
    v_mul_f32 v15, s60, v14
    v_fma_f32 v16, v14, s60, -v15
    v_fma_f32 v16, v14, s61, v16
    v_exp_f32 v15, v15
    v_mul_f32 v16, s62, v16
    v_fma_f32 v15, v15, v16, v15
    v_cvt_pk_bf16_f32 v15, v15, v15
    v_lshlrev_b32 v14, 16, v15
    s_cmp_lt_u32 s5, 4
    s_cbranch_scc0 K1_X
    v_and_b32 v6, 15, v1
    s_lshl_b32 s44, s7, 4
    v_add_u32 v6, s44, v6
    v_lshrrev_b32 v112, 1, v7
    v_lshl_add_u32 v112, v112, 5, v6
    v_and_b32 v113, 1, v7
    v_lshlrev_b32 v113, 3, v113
    v_lshl_add_u32 v112, v112, 4, v113
    s_add_u32 s44, s67, 4634
    v_add_u32 v112, s44, v112
    v_mul_u32_u24 v113, 43, v1
    v_lshrrev_b32 v113, 7, v113
    v_mul_u32_u24 v113, 1208, v113
    v_lshl_add_u32 v113, v1, 1, v113
    s_add_u32 s44, s67, 5664
    v_add_u32 v113, s44, v113
    v_mov_b32 v17, 0x00003c00
    ds_write_b32 v5, v17 offset:13056
    s_lshl_b32 s44, s45, 5
    s_lshr_b32 s49, s5, 1
    s_lshl_b32 s49, s49, 4
    s_add_u32 s44, s44, s49
    s_lshl_b32 s49, s7, 13
    s_add_u32 s44, s44, s49
    s_add_u32 s44, s44, 0x541000
    buffer_load_dwordx4 v130, s[80:83], s70 offen lds
    s_add_u32 m0, s71, 1024
    s_add_u32 s70, s70, 8192
    buffer_load_dwordx4 v130, s[80:83], s70 offen lds
    s_mov_b32 s50, s67
    v_and_b32 v220, 15, v1
    v_lshrrev_b32 v221, 4, v1
    v_sub_u32 v222, 16, v220
    v_and_b32 v223, 3, v222
    v_sub_u32 v222, v222, v223
    v_lshlrev_b32 v222, 1, v222
    v_mul_u32_u24 v223, 1216, v223
    v_add_u32 v222, v222, v223
    v_lshl_add_u32 v222, v221, 4, v222
    s_and_b32 s52, s5, 1
    s_lshl_b32 s51, s52, 6
    s_add_u32 s51, s51, s50
    s_add_u32 s51, s51, 4608
    v_add_u32 v222, s51, v222
    v_lshlrev_b32 v223, 5, v220
    s_add_u32 s51, s50, 480
    v_sub_u32 v223, s51, v223
    v_lshl_add_u32 v223, v221, 4, v223
    v_and_b32 v227, 1, v220
    v_lshlrev_b32 v228, 2, v220
    v_lshlrev_b32 v229, 3, v221
    v_sub_u32 v229, v229, v228
    s_add_u32 s51, s50, 9472
    v_add_u32 v229, s51, v229
    v_mul_u32_u24 v228, 380, v227
    v_add_u32 v224, 440, v229
    v_sub_u32 v224, v224, v228
    v_add_u32 v225, 704, v229
    v_add_u32 v225, v225, v228
    v_sub_u32 v227, 0, v220
    v_and_b32 v227, 3, v227
    v_mul_u32_u24 v227, 318, v227
    v_lshlrev_b32 v228, 1, v220
    v_sub_u32 v227, v227, v228
    v_lshl_add_u32 v227, v221, 3, v227
    s_add_u32 s51, s51, 1312
    v_add_u32 v226, s51, v227
    v_lshrrev_b32 v229, 2, v1
    v_and_b32 v230, 3, v1
    v_lshlrev_b32 v230, 3, v230
    s_add_u32 s51, s50, 14584
    v_add_u32 v227, s51, v230
    v_lshlrev_b32 v231, 4, v229
    v_sub_u32 v227, v227, v231
    s_add_u32 s51, s50, 24176
    v_add_u32 v228, s51, v230
    v_lshlrev_b32 v231, 5, v229
    v_sub_u32 v228, v228, v231
    v_mul_u32_u24 v229, 64, v220
    s_mul_i32 s51, s52, 8192
    s_add_u32 s51, s51, s50
    s_add_u32 s51, s51, 31168
    v_sub_u32 v229, s51, v229
    v_lshl_add_u32 v229, v221, 4, v229
    v_lshrrev_b32 v230, 3, v229
    v_and_b32 v230, 32, v230
    v_xor_b32 v229, v229, v230
    v_lshlrev_b32 v230, 3, v221
    v_sub_u32 v230, v220, v230
    v_add_u32 v230, 4, v230
    v_lshlrev_b32 v230, v230, 3
    v_bfe_i32 v232, v230, 1, 1
    v_bfe_i32 v236, v230, 2, 1
    v_bfe_i32 v233, v230, 3, 1
    v_bfe_i32 v237, v230, 4, 1
    v_bfe_i32 v234, v230, 5, 1
    v_bfe_i32 v238, v230, 6, 1
    v_bfe_i32 v235, v230, 7, 1
    v_bfe_i32 v239, v230, 8, 1
    s_mov_b32 s59, 0xffff
    v_bfi_b32 v232, s59, v232, v236
    v_bfi_b32 v233, s59, v233, v237
    v_bfi_b32 v234, s59, v234, v238
    v_bfi_b32 v235, s59, v235, v239
    s_add_u32 s51, s50, 9472
    v_mov_b32 v230, s51
    s_mov_b32 s42, 0x3f803f80
    s_mov_b32 s43, 0x3b000000
    s_setprio 3
    v_mov_b32 v146, s100
    v_mov_b32 v147, s101
    v_mov_b32 v150, s100
    v_mov_b32 v151, s101
    v_mov_b32 v154, s100
    v_mov_b32 v155, s101
    v_mov_b32 v158, s100
    v_mov_b32 v159, s101
    s_waitcnt vmcnt(4)
    v_dot2_f32_bf16 v160, v136, s42, 0
    v_dot2_f32_bf16 v161, v140, s42, 0
    v_dot2_f32_bf16 v162, v136, v136, 0
    v_dot2_f32_bf16 v163, v140, v140, 0
    v_dot2_f32_bf16 v160, v137, s42, v160
    v_dot2_f32_bf16 v161, v141, s42, v161
    v_dot2_f32_bf16 v162, v137, v137, v162
    v_dot2_f32_bf16 v163, v141, v141, v163
    v_dot2_f32_bf16 v160, v138, s42, v160
    v_dot2_f32_bf16 v161, v142, s42, v161
    v_dot2_f32_bf16 v162, v138, v138, v162
    v_dot2_f32_bf16 v163, v142, v142, v163
    v_dot2_f32_bf16 v160, v139, s42, v160
    v_dot2_f32_bf16 v161, v143, s42, v161
    v_dot2_f32_bf16 v162, v139, v139, v162
    v_dot2_f32_bf16 v163, v143, v143, v163
    v_mov_b32 v170, s100
    v_mov_b32 v171, s101
    s_nop 1
    v_add_f32_dpp v160, v160, v160 row_shr:1 row_mask:0xf bank_mask:0xf bound_ctrl:0
    v_add_f32_dpp v161, v161, v161 row_shr:1 row_mask:0xf bank_mask:0xf bound_ctrl:0
    v_add_f32_dpp v162, v162, v162 row_shr:1 row_mask:0xf bank_mask:0xf bound_ctrl:0
    v_add_f32_dpp v163, v163, v163 row_shr:1 row_mask:0xf bank_mask:0xf bound_ctrl:0
    v_add_f32_dpp v160, v160, v160 row_shr:2 row_mask:0xf bank_mask:0xf bound_ctrl:0
    v_add_f32_dpp v161, v161, v161 row_shr:2 row_mask:0xf bank_mask:0xf bound_ctrl:0
    v_add_f32_dpp v162, v162, v162 row_shr:2 row_mask:0xf bank_mask:0xf bound_ctrl:0
    v_add_f32_dpp v163, v163, v163 row_shr:2 row_mask:0xf bank_mask:0xf bound_ctrl:0
    v_add_f32_dpp v160, v160, v160 row_shr:4 row_mask:0xf bank_mask:0xf bound_ctrl:0
    v_add_f32_dpp v161, v161, v161 row_shr:4 row_mask:0xf bank_mask:0xf bound_ctrl:0
    v_add_f32_dpp v162, v162, v162 row_shr:4 row_mask:0xf bank_mask:0xf bound_ctrl:0
    v_add_f32_dpp v163, v163, v163 row_shr:4 row_mask:0xf bank_mask:0xf bound_ctrl:0
    v_add_f32_dpp v160, v160, v160 row_shr:8 row_mask:0xf bank_mask:0xf bound_ctrl:0
    v_add_f32_dpp v161, v161, v161 row_shr:8 row_mask:0xf bank_mask:0xf bound_ctrl:0
    v_add_f32_dpp v162, v162, v162 row_shr:8 row_mask:0xf bank_mask:0xf bound_ctrl:0
    v_add_f32_dpp v163, v163, v163 row_shr:8 row_mask:0xf bank_mask:0xf bound_ctrl:0
    v_add_f32_dpp v160, v160, v160 row_bcast:15 row_mask:0xa bank_mask:0xf
    v_add_f32_dpp v161, v161, v161 row_bcast:15 row_mask:0xa bank_mask:0xf
    v_add_f32_dpp v162, v162, v162 row_bcast:15 row_mask:0xa bank_mask:0xf
    v_add_f32_dpp v163, v163, v163 row_bcast:15 row_mask:0xa bank_mask:0xf
    v_add_f32_dpp v160, v160, v160 row_bcast:31 row_mask:0xc bank_mask:0xf
    v_add_f32_dpp v161, v161, v161 row_bcast:31 row_mask:0xc bank_mask:0xf
    v_add_f32_dpp v162, v162, v162 row_bcast:31 row_mask:0xc bank_mask:0xf
    v_add_f32_dpp v163, v163, v163 row_bcast:31 row_mask:0xc bank_mask:0xf
    v_pk_mul_f32 v[160:161], v[160:161], s[42:43] op_sel:[0,1] op_sel_hi:[1,1]
    v_pk_mul_f32 v[162:163], v[162:163], s[42:43] op_sel:[0,1] op_sel_hi:[1,1]
    v_pk_fma_f32 v[162:163], v[160:161], v[160:161], v[162:163] neg_lo:[1,0,0] neg_hi:[1,0,0]
    v_max_f32 v162, 0, v162
    v_max_f32 v163, 0, v163
    v_cvt_pk_bf16_f32 v165, v162, v163
    v_lshlrev_b32 v162, 16, v165
    v_and_b32 v163, 0xffff0000, v165
    v_add_f32 v162, 0x3727c5ac, v162
    v_add_f32 v163, 0x3727c5ac, v163
    v_cvt_pk_bf16_f32 v165, v162, v163
    v_lshlrev_b32 v162, 16, v165
    v_and_b32 v163, 0xffff0000, v165
    v_sqrt_f32 v162, v162
    v_sqrt_f32 v163, v163
    s_nop 0
    v_cvt_pk_bf16_f32 v168, v160, v162
    v_cvt_pk_bf16_f32 v169, v161, v163
    s_mov_b32 exec_lo, 0
    s_mov_b32 exec_hi, 0x80000000
    buffer_store_dwordx4 v[168:171], off, s[12:15], s44 sc1
    s_mov_b64 exec, -1
    s_setprio 0
    s_waitcnt vmcnt(1)
    ds_read2_b32 v[144:145], v126 offset0:0 offset1:32
    ds_read2_b32 v[148:149], v128 offset0:0 offset1:32
    ds_read2_b32 v[152:153], v114 offset0:0 offset1:32
    ds_read2_b32 v[156:157], v115 offset0:0 offset1:32
    v_lshlrev_b32 v8, 16, v8
    v_lshlrev_b32 v9, 16, v9
    v_mul_f32 v16, s60, v8
    v_fma_f32 v17, v8, s60, -v16
    v_fma_f32 v17, v8, s61, v17
    v_exp_f32 v16, v16
    v_mul_f32 v17, s62, v17
    v_fma_f32 v16, v16, v17, v16
    v_cvt_pk_bf16_f32 v16, v16, v16
    v_lshlrev_b32 v8, 16, v16
    v_mul_f32 v9, v9, v14
    v_mul_f32 v8, v8, v14
    s_waitcnt lgkmcnt(3)
    buffer_store_dwordx4 v[144:147], v127, s[12:15], s68 offen sc1
    s_add_u32 s68, s68, 132096
    s_waitcnt lgkmcnt(2)
    buffer_store_dwordx4 v[148:151], v127, s[12:15], s68 offen sc1
    s_add_u32 s68, s68, 132096
    s_waitcnt lgkmcnt(1)
    buffer_store_dwordx4 v[152:155], v127, s[12:15], s68 offen sc1
    s_add_u32 s68, s68, 132096
    s_waitcnt lgkmcnt(0)
    buffer_store_dwordx4 v[156:159], v127, s[12:15], s68 offen sc1
    v_mul_f32 v40, 0xc138aa3b, v8
    v_mul_f32 v41, 0x3fa2f983, v9
    v_mul_f32 v42, 0xc238aa3b, v8
    v_mul_f32 v43, 0x40a2f983, v9
    v_mul_f32 v44, 0xc338aa3b, v8
    v_mul_f32 v45, 0x41a2f983, v9
    v_exp_f32 v40, v40
    v_fract_f32 v41, v41
    v_exp_f32 v42, v42
    v_fract_f32 v43, v43
    v_exp_f32 v44, v44
    v_fract_f32 v45, v45
    v_cos_f32 v20, v41
    v_sin_f32 v21, v41
    v_cos_f32 v22, v43
    v_sin_f32 v23, v43
    v_cos_f32 v24, v45
    v_sin_f32 v25, v45
    s_nop 0
    v_mul_f32 v20, v20, v40
    v_mul_f32 v21, v21, v40
    v_mul_f32 v22, v22, v42
    v_mul_f32 v23, v23, v42
    v_mul_f32 v24, v24, v44
    v_mul_f32 v25, v25, v44
    v_pk_mul_f32 v[50:51], v[20:21], v[20:21] op_sel:[0,0] op_sel_hi:[1,0]
    v_pk_mul_f32 v[52:53], v[22:23], v[20:21] op_sel:[0,0] op_sel_hi:[1,0]
    v_pk_mul_f32 v[54:55], v[22:23], v[22:23] op_sel:[0,0] op_sel_hi:[1,0]
    v_pk_fma_f32 v[50:51], v[20:21], v[20:21], v[50:51] op_sel:[1,1,0] op_sel_hi:[0,1,1] neg_lo:[0,1,0]
    v_pk_fma_f32 v[52:53], v[22:23], v[20:21], v[52:53] op_sel:[1,1,0] op_sel_hi:[0,1,1] neg_lo:[0,1,0]
    v_pk_fma_f32 v[54:55], v[22:23], v[22:23], v[54:55] op_sel:[1,1,0] op_sel_hi:[0,1,1] neg_lo:[0,1,0]
    v_cvt_pk_f16_f32 v120, v20, v21
    ds_write_b32 v5, v120 offset:13600
    v_cvt_pk_f16_f32 v121, v22, v23
    ds_write_b32 v5, v121 offset:15232
    v_cvt_pk_f16_f32 v122, v24, v25
    ds_write_b32 v5, v122 offset:21760
    v_pk_mul_f32 v[56:57], v[50:51], v[20:21] op_sel:[0,0] op_sel_hi:[1,0]
    v_pk_mul_f32 v[58:59], v[22:23], v[50:51] op_sel:[0,0] op_sel_hi:[1,0]
    v_pk_mul_f32 v[60:61], v[54:55], v[22:23] op_sel:[0,0] op_sel_hi:[1,0]
    v_pk_fma_f32 v[56:57], v[50:51], v[20:21], v[56:57] op_sel:[1,1,0] op_sel_hi:[0,1,1] neg_lo:[0,1,0]
    v_pk_fma_f32 v[58:59], v[22:23], v[50:51], v[58:59] op_sel:[1,1,0] op_sel_hi:[0,1,1] neg_lo:[0,1,0]
    v_pk_fma_f32 v[60:61], v[54:55], v[22:23], v[60:61] op_sel:[1,1,0] op_sel_hi:[0,1,1] neg_lo:[0,1,0]
    v_cvt_pk_f16_f32 v123, v50, v51
    ds_write_b32 v5, v123 offset:14144
    v_cvt_pk_f16_f32 v124, v52, v53
    ds_write_b32 v5, v124 offset:15776
    v_cvt_pk_f16_f32 v125, v54, v55
    ds_write_b32 v5, v125 offset:17408
    v_pk_mul_f32 v[62:63], v[22:23], v[56:57] op_sel:[0,0] op_sel_hi:[1,0]
    v_pk_mul_f32 v[64:65], v[54:55], v[20:21] op_sel:[0,0] op_sel_hi:[1,0]
    v_pk_mul_f32 v[66:67], v[54:55], v[50:51] op_sel:[0,0] op_sel_hi:[1,0]
    v_pk_fma_f32 v[62:63], v[22:23], v[56:57], v[62:63] op_sel:[1,1,0] op_sel_hi:[0,1,1] neg_lo:[0,1,0]
    v_pk_fma_f32 v[64:65], v[54:55], v[20:21], v[64:65] op_sel:[1,1,0] op_sel_hi:[0,1,1] neg_lo:[0,1,0]
    v_pk_fma_f32 v[66:67], v[54:55], v[50:51], v[66:67] op_sel:[1,1,0] op_sel_hi:[0,1,1] neg_lo:[0,1,0]
    v_cvt_pk_f16_f32 v120, v56, v57
    ds_write_b32 v5, v120 offset:14688
    v_cvt_pk_f16_f32 v121, v58, v59
    ds_write_b32 v5, v121 offset:16320
    v_cvt_pk_f16_f32 v122, v60, v61
    ds_write_b32 v5, v122 offset:19584
    v_pk_mul_f32 v[68:69], v[54:55], v[56:57] op_sel:[0,0] op_sel_hi:[1,0]
    v_pk_mul_f32 v[70:71], v[60:61], v[20:21] op_sel:[0,0] op_sel_hi:[1,0]
    v_pk_mul_f32 v[72:73], v[60:61], v[50:51] op_sel:[0,0] op_sel_hi:[1,0]
    v_pk_fma_f32 v[68:69], v[54:55], v[56:57], v[68:69] op_sel:[1,1,0] op_sel_hi:[0,1,1] neg_lo:[0,1,0]
    v_pk_fma_f32 v[70:71], v[60:61], v[20:21], v[70:71] op_sel:[1,1,0] op_sel_hi:[0,1,1] neg_lo:[0,1,0]
    v_pk_fma_f32 v[72:73], v[60:61], v[50:51], v[72:73] op_sel:[1,1,0] op_sel_hi:[0,1,1] neg_lo:[0,1,0]
    v_cvt_pk_f16_f32 v123, v62, v63
    ds_write_b32 v5, v123 offset:16864
    v_cvt_pk_f16_f32 v124, v64, v65
    ds_write_b32 v5, v124 offset:17952
    v_cvt_pk_f16_f32 v125, v66, v67
    ds_write_b32 v5, v125 offset:18496
    v_pk_mul_f32 v[74:75], v[60:61], v[56:57] op_sel:[0,0] op_sel_hi:[1,0]
    v_pk_mul_f32 v[76:77], v[24:25], v[20:21] op_sel:[0,0] op_sel_hi:[1,0]
    v_pk_mul_f32 v[78:79], v[24:25], v[50:51] op_sel:[0,0] op_sel_hi:[1,0]
    v_pk_fma_f32 v[74:75], v[60:61], v[56:57], v[74:75] op_sel:[1,1,0] op_sel_hi:[0,1,1] neg_lo:[0,1,0]
    v_pk_fma_f32 v[76:77], v[24:25], v[20:21], v[76:77] op_sel:[1,1,0] op_sel_hi:[0,1,1] neg_lo:[0,1,0]
    v_pk_fma_f32 v[78:79], v[24:25], v[50:51], v[78:79] op_sel:[1,1,0] op_sel_hi:[0,1,1] neg_lo:[0,1,0]
    v_cvt_pk_f16_f32 v120, v68, v69
    ds_write_b32 v5, v120 offset:19040
    v_cvt_pk_f16_f32 v121, v70, v71
    ds_write_b32 v5, v121 offset:20128
    v_cvt_pk_f16_f32 v122, v72, v73
    ds_write_b32 v5, v122 offset:20672
    v_pk_mul_f32 v[80:81], v[24:25], v[56:57] op_sel:[0,0] op_sel_hi:[1,0]
    v_pk_mul_f32 v[82:83], v[24:25], v[22:23] op_sel:[0,0] op_sel_hi:[1,0]
    v_pk_mul_f32 v[84:85], v[24:25], v[52:53] op_sel:[0,0] op_sel_hi:[1,0]
    v_pk_fma_f32 v[80:81], v[24:25], v[56:57], v[80:81] op_sel:[1,1,0] op_sel_hi:[0,1,1] neg_lo:[0,1,0]
    v_pk_fma_f32 v[82:83], v[24:25], v[22:23], v[82:83] op_sel:[1,1,0] op_sel_hi:[0,1,1] neg_lo:[0,1,0]
    v_pk_fma_f32 v[84:85], v[24:25], v[52:53], v[84:85] op_sel:[1,1,0] op_sel_hi:[0,1,1] neg_lo:[0,1,0]
    v_cvt_pk_f16_f32 v123, v74, v75
    ds_write_b32 v5, v123 offset:21216
    v_cvt_pk_f16_f32 v124, v76, v77
    ds_write_b32 v5, v124 offset:22304
    v_cvt_pk_f16_f32 v125, v78, v79
    ds_write_b32 v5, v125 offset:22848
    v_pk_mul_f32 v[86:87], v[24:25], v[58:59] op_sel:[0,0] op_sel_hi:[1,0]
    v_pk_mul_f32 v[88:89], v[24:25], v[62:63] op_sel:[0,0] op_sel_hi:[1,0]
    v_pk_mul_f32 v[90:91], v[24:25], v[54:55] op_sel:[0,0] op_sel_hi:[1,0]
    v_pk_fma_f32 v[86:87], v[24:25], v[58:59], v[86:87] op_sel:[1,1,0] op_sel_hi:[0,1,1] neg_lo:[0,1,0]
    v_pk_fma_f32 v[88:89], v[24:25], v[62:63], v[88:89] op_sel:[1,1,0] op_sel_hi:[0,1,1] neg_lo:[0,1,0]
    v_pk_fma_f32 v[90:91], v[24:25], v[54:55], v[90:91] op_sel:[1,1,0] op_sel_hi:[0,1,1] neg_lo:[0,1,0]
    v_cvt_pk_f16_f32 v120, v80, v81
    ds_write_b32 v5, v120 offset:23392
    v_cvt_pk_f16_f32 v121, v82, v83
    ds_write_b32 v5, v121 offset:23936
    v_cvt_pk_f16_f32 v122, v84, v85
    ds_write_b32 v5, v122 offset:24480
    v_pk_mul_f32 v[92:93], v[24:25], v[64:65] op_sel:[0,0] op_sel_hi:[1,0]
    v_pk_mul_f32 v[94:95], v[24:25], v[66:67] op_sel:[0,0] op_sel_hi:[1,0]
    v_pk_mul_f32 v[96:97], v[24:25], v[68:69] op_sel:[0,0] op_sel_hi:[1,0]
    v_pk_fma_f32 v[92:93], v[24:25], v[64:65], v[92:93] op_sel:[1,1,0] op_sel_hi:[0,1,1] neg_lo:[0,1,0]
    v_pk_fma_f32 v[94:95], v[24:25], v[66:67], v[94:95] op_sel:[1,1,0] op_sel_hi:[0,1,1] neg_lo:[0,1,0]
    v_pk_fma_f32 v[96:97], v[24:25], v[68:69], v[96:97] op_sel:[1,1,0] op_sel_hi:[0,1,1] neg_lo:[0,1,0]
    v_cvt_pk_f16_f32 v123, v86, v87
    ds_write_b32 v5, v123 offset:25024
    v_cvt_pk_f16_f32 v124, v88, v89
    ds_write_b32 v5, v124 offset:25568
    v_cvt_pk_f16_f32 v125, v90, v91
    ds_write_b32 v5, v125 offset:26112
    v_pk_mul_f32 v[98:99], v[24:25], v[60:61] op_sel:[0,0] op_sel_hi:[1,0]
    v_pk_mul_f32 v[100:101], v[24:25], v[70:71] op_sel:[0,0] op_sel_hi:[1,0]
    v_pk_mul_f32 v[102:103], v[24:25], v[72:73] op_sel:[0,0] op_sel_hi:[1,0]
    v_pk_fma_f32 v[98:99], v[24:25], v[60:61], v[98:99] op_sel:[1,1,0] op_sel_hi:[0,1,1] neg_lo:[0,1,0]
    v_pk_fma_f32 v[100:101], v[24:25], v[70:71], v[100:101] op_sel:[1,1,0] op_sel_hi:[0,1,1] neg_lo:[0,1,0]
    v_pk_fma_f32 v[102:103], v[24:25], v[72:73], v[102:103] op_sel:[1,1,0] op_sel_hi:[0,1,1] neg_lo:[0,1,0]
    v_cvt_pk_f16_f32 v120, v92, v93
    ds_write_b32 v5, v120 offset:26656
    v_cvt_pk_f16_f32 v121, v94, v95
    ds_write_b32 v5, v121 offset:27200
    v_cvt_pk_f16_f32 v122, v96, v97
    ds_write_b32 v5, v122 offset:27744
    v_pk_mul_f32 v[104:105], v[24:25], v[74:75] op_sel:[0,0] op_sel_hi:[1,0]
    v_pk_fma_f32 v[104:105], v[24:25], v[74:75], v[104:105] op_sel:[1,1,0] op_sel_hi:[0,1,1] neg_lo:[0,1,0]
    v_cvt_pk_f16_f32 v123, v98, v99
    ds_write_b32 v5, v123 offset:28288
    v_cvt_pk_f16_f32 v124, v100, v101
    ds_write_b32 v5, v124 offset:28832
    v_cvt_pk_f16_f32 v125, v102, v103
    ds_write_b32 v5, v125 offset:29376
    v_cvt_pk_f16_f32 v120, v104, v105
    ds_write_b32 v5, v120 offset:29920
    buffer_store_dwordx4 v[176:179], v132, s[12:15], s84 offen sc1
    buffer_store_dwordx4 v[176:179], v132, s[12:15], s85 offen sc1
    s_mov_b64 exec, 0xff
    buffer_store_dwordx4 v[180:183], v131, s[12:15], s86 offen sc1
    s_mov_b64 exec, -1
    s_branch K1_MM
K1_X:
    v_and_b32 v6, 15, v1
    s_lshl_b32 s44, s7, 4
    v_add_u32 v6, s44, v6
    v_lshl_add_u32 v112, v7, 5, v6
    v_lshlrev_b32 v112, 1, v112
    s_add_u32 s44, s67, 9662
    v_sub_u32 v112, s44, v112
    v_lshrrev_b32 v113, 1, v6
    v_lshl_add_u32 v113, v7, 5, v113
    v_lshlrev_b32 v113, 1, v113
    v_and_b32 v6, 1, v6
    v_mul_u32_u24 v6, 1280, v6
    v_add_u32 v113, v6, v113
    s_add_u32 s44, s67, 12128
    v_sub_u32 v113, s44, v113
    s_mov_b32 s70, s4
    s_sub_u32 s51, s5, 4
    v_lshrrev_b32 v234, 4, v1
    v_and_b32 v233, 1, v1
    v_lshlrev_b32 v235, 3, v234
    v_lshl_add_u32 v235, v233, 5, v235
    v_mul_u32_u24 v234, 4160, v1
    s_add_u32 s52, s67, 17424
    v_add_u32 v234, s52, v234
    s_mov_b32 s52, s86
    v_mov_b32 v200, 0
    v_mov_b32 v201, 0
    v_mov_b32 v202, 0
    v_mov_b32 v203, 0
    s_and_b32 s88, s2, 7
    s_lshr_b32 s83, s2, 3
    s_lshl_b32 s88, s88, 1
    s_sub_u32 s83, s83, 4
    s_sub_u32 s89, s83, 14
    s_cmp_lt_u32 s83, 14
    s_cselect_b32 s89, s83, s89
    s_subb_u32 s88, s88, -1
    s_lshl_b32 s88, s88, 17
    s_add_u32 s88, s88, 0x200000
    v_lshrrev_b32 v237, 4, v1
    v_and_b32 v238, 15, v1
    v_lshlrev_b32 v236, 2, v237
    v_xor_b32 v238, v236, v238
    v_lshlrev_b32 v238, 4, v238
    v_lshl_add_u32 v236, v237, 8, v238
    v_mul_u32_u24 v237, 3584, v237
    v_add_u32 v237, v237, v238
    v_add_u32 v238, 13312, v237
    v_add_u32 v239, 26624, v237
    v_add_u32 v240, 39936, v237
    s_lshl_b32 s71, s51, 12
    s_add_u32 s88, s88, s71
    s_lshl_b32 s89, s89, 8
    s_mul_i32 s83, s51, 57344
    s_add_u32 s89, s89, s83
    v_mov_b32 v232, -1
    v_mov_b32 v233, -1
    s_cmp_lt_u32 s4, 28
    s_cselect_b32 s43, s52, 0x55e000
    s_mov_b32 exec_lo, 0x00030003
    s_mov_b32 exec_hi, 0x00030003
    buffer_store_dwordx2 v[232:233], v235, s[12:15], s43 offen sc1
    s_mov_b64 exec, -1
    s_waitcnt vmcnt(1)
    v_and_b32 v15, 0x7fff, v10
    v_and_b32 v16, 0x7fff, v11
    v_and_b32 v17, 0x7fff, v12
    v_and_b32 v13, 0x7fff, v13
    v_max_u32 v15, v15, v16
    v_max_u32 v17, v17, v13
    v_max_u32 v15, v15, v17
    v_lshlrev_b32 v8, 16, v8
    v_lshlrev_b32 v9, 16, v9
    v_max_u32_dpp v15, v15, v15 row_shr:1 row_mask:0xf bank_mask:0xf bound_ctrl:0
    v_mul_f32 v16, s60, v8
    v_fma_f32 v17, v8, s60, -v16
    v_max_u32_dpp v15, v15, v15 row_shr:2 row_mask:0xf bank_mask:0xf bound_ctrl:0
    v_fma_f32 v17, v8, s61, v17
    v_exp_f32 v16, v16
    v_max_u32_dpp v15, v15, v15 row_shr:4 row_mask:0xf bank_mask:0xf bound_ctrl:0
    v_mul_f32 v17, s62, v17
    v_fma_f32 v16, v16, v17, v16
    v_max_u32_dpp v15, v15, v15 row_shr:8 row_mask:0xf bank_mask:0xf bound_ctrl:0
    v_cvt_pk_bf16_f32 v16, v16, v16
    v_lshlrev_b32 v8, 16, v16
    v_max_u32_dpp v15, v15, v15 row_bcast:15 row_mask:0xa bank_mask:0xf
    v_mul_f32 v9, v9, v14
    v_mul_f32 v8, v8, v14
    v_max_u32_dpp v15, v15, v15 row_bcast:31 row_mask:0xc bank_mask:0xf
    v_lshlrev_b32 v10, 16, v10
    v_lshlrev_b32 v11, 16, v11
    v_readlane_b32 s46, v15, 63
    v_mul_f32 v40, 0xbfb8aa3b, v8
    v_mul_f32 v41, 0x3e22f983, v9
    v_mul_f32 v42, 0xc138aa3b, v8
    v_mul_f32 v43, 0x3fa2f983, v9
    v_mul_f32 v44, 0xc3b8aa3b, v8
    v_mul_f32 v45, 0x4222f983, v9
    v_exp_f32 v40, v40
    v_fract_f32 v41, v41
    v_exp_f32 v42, v42
    v_fract_f32 v43, v43
    v_exp_f32 v44, v44
    v_fract_f32 v45, v45
    v_cos_f32 v20, v41
    v_sin_f32 v21, v41
    v_cos_f32 v22, v43
    v_sin_f32 v23, v43
    v_cos_f32 v24, v45
    v_sin_f32 v25, v45
    s_nop 0
    v_mul_f32 v20, v20, v40
    v_mul_f32 v21, v21, v40
    v_mul_f32 v22, v22, v42
    v_mul_f32 v23, v23, v42
    v_mul_f32 v24, v24, v44
    v_mul_f32 v25, v25, v44
    s_lshr_b32 s46, s46, 7
    s_min_u32 s46, s46, 253
    s_max_u32 s46, s46, 1
    s_sub_u32 s47, 254, s46
    s_lshl_b32 s47, s47, 23
    s_lshl_b32 s46, s46, 23
    v_mul_f32 v30, s47, v10
    v_mul_f32 v31, s47, v11
    v_mul_f32 v16, s46, v14
    v_add_f32 v16, v16, v16
    s_lshl_b32 s44, s6, 2
    v_mov_b32 v17, s44
    v_add_u32 v17, 107520, v17
    ds_write_b32 v17, v16
    v_pk_mul_f32 v[50:51], v[20:21], v[20:21] op_sel:[0,0] op_sel_hi:[1,0]
    v_pk_mul_f32 v[52:53], v[30:31], v[24:25] op_sel:[0,0] op_sel_hi:[1,0]
    v_pk_mul_f32 v[54:55], v[30:31], v[20:21] op_sel:[0,0] op_sel_hi:[1,0]
    v_pk_fma_f32 v[50:51], v[20:21], v[20:21], v[50:51] op_sel:[1,1,0] op_sel_hi:[0,1,1] neg_lo:[0,1,0]
    v_pk_fma_f32 v[52:53], v[30:31], v[24:25], v[52:53] op_sel:[1,1,0] op_sel_hi:[0,1,1] neg_lo:[0,1,0]
    v_pk_fma_f32 v[54:55], v[30:31], v[20:21], v[54:55] op_sel:[1,1,0] op_sel_hi:[0,1,1] neg_lo:[0,1,0]
    v_cvt_pk_f16_f32 v121, v30, -v31
    ds_write_b32 v5, v121 offset:0
    v_pk_mul_f32 v[56:57], v[50:51], v[50:51] op_sel:[0,0] op_sel_hi:[1,0]
    v_pk_mul_f32 v[58:59], v[52:53], v[22:23] op_sel:[0,0] op_sel_hi:[1,0]
    v_pk_mul_f32 v[60:61], v[30:31], v[50:51] op_sel:[0,0] op_sel_hi:[1,0]
    v_pk_fma_f32 v[56:57], v[50:51], v[50:51], v[56:57] op_sel:[1,1,0] op_sel_hi:[0,1,1] neg_lo:[0,1,0]
    v_pk_fma_f32 v[58:59], v[52:53], v[22:23], v[58:59] op_sel:[1,1,0] op_sel_hi:[0,1,1] neg_lo:[0,1,0]
    v_pk_fma_f32 v[60:61], v[30:31], v[50:51], v[60:61] op_sel:[1,1,0] op_sel_hi:[0,1,1] neg_lo:[0,1,0]
    v_cvt_pk_f16_f32 v122, v52, -v53
    ds_write_b32 v5, v122 offset:4352
    ds_write_b32 v5, v122 offset:4896
    v_cvt_pk_f16_f32 v123, v54, -v55
    ds_write_b32 v5, v123 offset:544
    v_pk_mul_f32 v[62:63], v[54:55], v[50:51] op_sel:[0,0] op_sel_hi:[1,0]
    v_pk_mul_f32 v[64:65], v[58:59], v[24:25] op_sel:[0,0] op_sel_hi:[1,0]
    v_pk_mul_f32 v[66:67], v[30:31], v[56:57] op_sel:[0,0] op_sel_hi:[1,0]
    v_pk_fma_f32 v[62:63], v[54:55], v[50:51], v[62:63] op_sel:[1,1,0] op_sel_hi:[0,1,1] neg_lo:[0,1,0]
    v_pk_fma_f32 v[64:65], v[58:59], v[24:25], v[64:65] op_sel:[1,1,0] op_sel_hi:[0,1,1] neg_lo:[0,1,0]
    v_pk_fma_f32 v[66:67], v[30:31], v[56:57], v[66:67] op_sel:[1,1,0] op_sel_hi:[0,1,1] neg_lo:[0,1,0]
    v_cvt_pk_f16_f32 v124, v58, -v59
    ds_write_b32 v5, v124 offset:8160
    v_cvt_pk_f16_f32 v125, v60, -v61
    ds_write_b32 v5, v125 offset:1088
    v_pk_mul_f32 v[68:69], v[54:55], v[56:57] op_sel:[0,0] op_sel_hi:[1,0]
    v_pk_mul_f32 v[70:71], v[64:65], v[24:25] op_sel:[0,0] op_sel_hi:[1,0]
    v_pk_mul_f32 v[72:73], v[52:53], v[56:57] op_sel:[0,0] op_sel_hi:[1,0]
    v_pk_fma_f32 v[68:69], v[54:55], v[56:57], v[68:69] op_sel:[1,1,0] op_sel_hi:[0,1,1] neg_lo:[0,1,0]
    v_pk_fma_f32 v[70:71], v[64:65], v[24:25], v[70:71] op_sel:[1,1,0] op_sel_hi:[0,1,1] neg_lo:[0,1,0]
    v_pk_fma_f32 v[72:73], v[52:53], v[56:57], v[72:73] op_sel:[1,1,0] op_sel_hi:[0,1,1] neg_lo:[0,1,0]
    v_cvt_pk_f16_f32 v120, v62, -v63
    ds_write_b32 v5, v120 offset:1632
    v_cvt_pk_f16_f32 v121, v64, -v65
    ds_write_b32 v5, v121 offset:9248
    v_cvt_pk_f16_f32 v122, v66, -v67
    ds_write_b32 v5, v122 offset:2176
    v_pk_mul_f32 v[74:75], v[60:61], v[56:57] op_sel:[0,0] op_sel_hi:[1,0]
    v_pk_mul_f32 v[76:77], v[70:71], v[24:25] op_sel:[0,0] op_sel_hi:[1,0]
    v_pk_mul_f32 v[78:79], v[72:73], v[24:25] op_sel:[0,0] op_sel_hi:[1,0]
    v_pk_fma_f32 v[74:75], v[60:61], v[56:57], v[74:75] op_sel:[1,1,0] op_sel_hi:[0,1,1] neg_lo:[0,1,0]
    v_pk_fma_f32 v[76:77], v[70:71], v[24:25], v[76:77] op_sel:[1,1,0] op_sel_hi:[0,1,1] neg_lo:[0,1,0]
    v_pk_fma_f32 v[78:79], v[72:73], v[24:25], v[78:79] op_sel:[1,1,0] op_sel_hi:[0,1,1] neg_lo:[0,1,0]
    v_cvt_pk_f16_f32 v123, v68, -v69
    ds_write_b32 v5, v123 offset:2720
    v_cvt_pk_f16_f32 v124, v70, -v71
    ds_write_b32 v5, v124 offset:11424
    v_cvt_pk_f16_f32 v125, v72, -v73
    ds_write_b32 v5, v125 offset:5984
    ds_write_b32 v5, v125 offset:6528
    ds_write_b32 v5, v125 offset:7072
    v_pk_mul_f32 v[80:81], v[62:63], v[56:57] op_sel:[0,0] op_sel_hi:[1,0]
    v_pk_mul_f32 v[82:83], v[76:77], v[24:25] op_sel:[0,0] op_sel_hi:[1,0]
    v_pk_mul_f32 v[84:85], v[52:53], v[50:51] op_sel:[0,0] op_sel_hi:[1,0]
    v_pk_fma_f32 v[80:81], v[62:63], v[56:57], v[80:81] op_sel:[1,1,0] op_sel_hi:[0,1,1] neg_lo:[0,1,0]
    v_pk_fma_f32 v[82:83], v[76:77], v[24:25], v[82:83] op_sel:[1,1,0] op_sel_hi:[0,1,1] neg_lo:[0,1,0]
    v_pk_fma_f32 v[84:85], v[52:53], v[50:51], v[84:85] op_sel:[1,1,0] op_sel_hi:[0,1,1] neg_lo:[0,1,0]
    v_cvt_pk_f16_f32 v120, v74, -v75
    ds_write_b32 v5, v120 offset:3264
    v_cvt_pk_f16_f32 v121, v76, -v77
    ds_write_b32 v5, v121 offset:9792
    v_cvt_pk_f16_f32 v122, v78, -v79
    ds_write_b32 v5, v122 offset:8704
    v_pk_mul_f32 v[86:87], v[78:79], v[24:25] op_sel:[0,0] op_sel_hi:[1,0]
    v_pk_mul_f32 v[88:89], v[82:83], v[24:25] op_sel:[0,0] op_sel_hi:[1,0]
    v_pk_mul_f32 v[90:91], v[84:85], v[56:57] op_sel:[0,0] op_sel_hi:[1,0]
    v_pk_fma_f32 v[86:87], v[78:79], v[24:25], v[86:87] op_sel:[1,1,0] op_sel_hi:[0,1,1] neg_lo:[0,1,0]
    v_pk_fma_f32 v[88:89], v[82:83], v[24:25], v[88:89] op_sel:[1,1,0] op_sel_hi:[0,1,1] neg_lo:[0,1,0]
    v_pk_fma_f32 v[90:91], v[84:85], v[56:57], v[90:91] op_sel:[1,1,0] op_sel_hi:[0,1,1] neg_lo:[0,1,0]
    v_cvt_pk_f16_f32 v123, v80, -v81
    ds_write_b32 v5, v123 offset:3808
    v_cvt_pk_f16_f32 v124, v82, -v83
    ds_write_b32 v5, v124 offset:10336
    v_cvt_pk_f16_f32 v125, v84, -v85
    ds_write_b32 v5, v125 offset:5440
    v_pk_mul_f32 v[92:93], v[88:89], v[24:25] op_sel:[0,0] op_sel_hi:[1,0]
    v_pk_fma_f32 v[92:93], v[88:89], v[24:25], v[92:93] op_sel:[1,1,0] op_sel_hi:[0,1,1] neg_lo:[0,1,0]
    v_cvt_pk_f16_f32 v120, v86, -v87
    ds_write_b32 v5, v120 offset:10880
    v_cvt_pk_f16_f32 v121, v88, -v89
    ds_write_b32 v5, v121 offset:11968
    v_cvt_pk_f16_f32 v122, v90, -v91
    ds_write_b32 v5, v122 offset:7616
    v_cvt_pk_f16_f32 v123, v92, -v93
    ds_write_b32 v5, v123 offset:12512
K1_MM:
    v_lshlrev_b32 v3, 4, v0
    s_mov_b32 s44, 0x541000
    s_mov_b32 s45, 0x543000
    s_lshr_b32 s3, s69, 2
    v_lshlrev_b32 v2, 5, v0
    s_mul_i32 s48, s3, 16512
    s_add_u32 s48, s48, 0x1000000
    s_waitcnt lgkmcnt(0)
    s_barrier
    ds_read_b128 v[32:35], v18 offset:0
    ds_read_b128 v[36:39], v19 offset:0
    ds_read_b128 v[40:43], v18 offset:64
    ds_read_b128 v[44:47], v19 offset:64
    ds_read_b128 v[48:51], v18 offset:128
    ds_read_b128 v[52:55], v19 offset:128
    ds_read_b128 v[56:59], v18 offset:192
    ds_read_b128 v[60:63], v19 offset:192
    ds_read_b128 v[64:67], v18 offset:256
    ds_read_b128 v[68:71], v19 offset:256
    ds_read_b128 v[72:75], v18 offset:320
    ds_read_b128 v[76:79], v19 offset:320
    ds_read_b128 v[80:83], v18 offset:384
    ds_read_b128 v[84:87], v19 offset:384
    v_lshlrev_b32 v5, 4, v1
    s_mov_b32 s50, s67
    s_lshl_b32 s46, s66, 16
    s_and_b32 s47, s66, 0xffff0000
    v_mov_b32 v12, 107520
    v_lshrrev_b32 v10, 1, v0
    v_sub_u32 v10, 255, v10
    v_and_b32 v11, 1, v0
    v_xor_b32 v11, 1, v11
    v_lshlrev_b32 v4, 4, v10
    v_lshl_add_u32 v4, v11, 3, v4
    v_lshrrev_b32 v14, 1, v10
    v_lshrrev_b32 v13, 3, v10
    v_xor_b32 v10, v10, v13
    v_mul_u32_u24 v14, 64, v14
    v_and_b32 v10, 1, v10
    v_lshl_add_u32 v14, v10, 5, v14
    v_lshl_add_u32 v14, v11, 4, v14
    v_add_u32 v13, 49664, v14
    v_lshrrev_b32 v10, 5, v0
    v_and_b32 v11, 31, v0
    v_lshlrev_b32 v10, 17, v10
    v_lshl_add_u32 v15, v11, 3, v10
    s_lshl_b32 s53, s3, 9
    s_add_u32 s53, s53, 0x200000
    s_and_b32 s49, s5, 1
    s_lshl_b32 s49, s49, 10
    s_add_u32 s49, s49, s50
    v_add_u32 v8, s49, v5
    s_waitcnt lgkmcnt(12)
    v_mfma_f32_16x16x32_f16 v[20:23], v[32:35], v[36:39], 0
    ds_read_b128 v[88:91], v18 offset:448
    ds_read_b128 v[92:95], v19 offset:448
    s_waitcnt lgkmcnt(12)
    v_mfma_f32_16x16x32_f16 v[24:27], v[40:43], v[44:47], 0
    s_waitcnt lgkmcnt(10)
    v_mfma_f32_16x16x32_f16 v[20:23], v[48:51], v[52:55], v[20:23]
    s_waitcnt lgkmcnt(8)
    v_mfma_f32_16x16x32_f16 v[24:27], v[56:59], v[60:63], v[24:27]
    s_waitcnt lgkmcnt(6)
    v_mfma_f32_16x16x32_f16 v[20:23], v[64:67], v[68:71], v[20:23]
    s_waitcnt lgkmcnt(4)
    v_mfma_f32_16x16x32_f16 v[24:27], v[72:75], v[76:79], v[24:27]
    s_waitcnt lgkmcnt(2)
    v_mfma_f32_16x16x32_f16 v[20:23], v[80:83], v[84:87], v[20:23]
    s_waitcnt lgkmcnt(0)
    v_mfma_f32_16x16x32_f16 v[24:27], v[88:91], v[92:95], v[24:27]
    s_cmp_lt_u32 s5, 4
    s_cbranch_scc0 P1_MSY
    buffer_load_dwordx4 v[164:167], v3, s[12:15], s44 offen
    buffer_load_dwordx4 v[168:171], v3, s[12:15], s45 offen
    buffer_load_dwordx4 v[156:159], v2, s[12:15], s48 offen
    buffer_load_dwordx4 v[160:163], v2, s[12:15], s48 offen offset:16
P1_MSY:
    s_nop 4
    s_nop 3
    v_add_f32 v20, v20, v24
    v_add_f32 v21, v21, v25
    v_add_f32 v22, v22, v26
    v_add_f32 v23, v23, v27
    v_cvt_pk_f16_f32 v28, v20, v21
    v_cvt_pk_f16_f32 v29, v22, v23
    s_cmp_lt_u32 s5, 4
    s_cbranch_scc0 K1_ST1
    v_alignbit_b32 v30, v29, v28, 16
    v_readlane_b32 s43, v29, 63
    ds_write_b64 v112, v[28:29] offset:6
    ds_write_b32 v112, v28 offset:2434
    ds_write_b32 v112, v29 offset:2438
    ds_write_b16 v112, v28 offset:1220
    ds_write_b32 v112, v30 offset:1222
    ds_write_b16_d16_hi v112, v29 offset:1226
    ds_write_b16 v112, v28 offset:3648
    ds_write_b32 v112, v30 offset:3650
    ds_write_b16_d16_hi v112, v29 offset:3654
    s_cmp_eq_u32 s7, 0
    s_cbranch_scc1 K1_STD
    v_mov_b32 v31, s43
    s_mov_b64 exec, 0xfff
    ds_write_b16_d16_hi v113, v31
    s_mov_b64 exec, -1
    s_branch K1_STD
K1_ST1:
    s_mov_b32 exec_hi, 0
    ds_write_b16_d16_hi v112, v28 offset:0
    ds_write_b16_d16_hi v112, v28 offset:380
    ds_write_b16 v112, v28 offset:644
    ds_write_b16 v112, v28 offset:1024
    ds_write_b16 v113, v29 offset:32
    ds_write_b16_d16_hi v113, v29 offset:0
    ds_write_b16 v113, v29 offset:350
    ds_write_b16_d16_hi v113, v29 offset:318
    ds_write_b16 v113, v29 offset:668
    ds_write_b16_d16_hi v113, v29 offset:636
    ds_write_b16 v113, v29 offset:986
    ds_write_b16_d16_hi v113, v29 offset:954
    s_mov_b32 exec_hi, -1
    buffer_load_dwordx4 v[164:167], v3, s[12:15], s44 offen
    buffer_load_dwordx4 v[168:171], v3, s[12:15], s45 offen
    buffer_load_dwordx4 v[156:159], v2, s[12:15], s48 offen
    buffer_load_dwordx4 v[160:163], v2, s[12:15], s48 offen offset:16
    s_cmp_lt_u32 s4, 4
    s_cbranch_scc1 P1_MSX
    s_add_u32 m0, s71, 114688
    s_add_u32 s83, s89, 0
    buffer_load_dwordx4 v237, s[72:75], s83 offen offset:0 lds
    buffer_load_dwordx4 v238, s[72:75], s83 offen offset:1024 lds
    buffer_load_dwordx4 v239, s[72:75], s83 offen offset:2048 lds
    buffer_load_dwordx4 v240, s[72:75], s83 offen offset:3072 lds
P1_MSX:
    s_mov_b64 exec, 0x3fff
    buffer_load_dword v250, v133, s[76:79], s87 offen
    s_mov_b64 exec, -1
K1_STD:
    s_cmp_ge_u32 s5, 4
    s_cbranch_scc1 K2_HELP
    s_mov_b32 s58, 0
    s_waitcnt vmcnt(0)
K2_MSA:
    v_cmp_ne_u64 vcc, s[100:101], v[166:167]
    v_cmp_ne_u64 s[56:57], s[100:101], v[170:171]
    v_cmp_ne_u64 s[54:55], s[100:101], v[158:159]
    v_cmp_ne_u64 s[42:43], s[100:101], v[162:163]
    s_add_u32 s58, s58, 1
    s_or_b64 s[56:57], s[56:57], s[54:55]
    s_or_b64 vcc, vcc, s[42:43]
    s_or_b64 vcc, vcc, s[56:57]
    s_cbranch_scc0 K2_MSOKA
    s_cmp_gt_u32 s58, 131072
    s_cbranch_scc1 K2_MSOKA
    buffer_load_dwordx4 v[164:167], v3, s[12:15], s44 offen sc1
    buffer_load_dwordx4 v[168:171], v3, s[12:15], s45 offen sc1
    buffer_load_dwordx4 v[156:159], v2, s[12:15], s48 offen sc1
    buffer_load_dwordx4 v[160:163], v2, s[12:15], s48 offen offset:16 sc1
    s_waitcnt vmcnt(0)
    s_branch K2_MSA
K2_MSOKA:
    v_and_b32 v193, 0xffff0000, v164
    v_lshlrev_b32 v192, 16, v164
    v_and_b32 v195, 0xffff0000, v165
    v_lshlrev_b32 v194, 16, v165
    v_and_b32 v197, 0xffff0000, v168
    v_lshlrev_b32 v196, 16, v168
    v_and_b32 v199, 0xffff0000, v169
    v_lshlrev_b32 v198, 16, v169
    v_rcp_f32 v193, v193
    v_rcp_f32 v195, v195
    v_rcp_f32 v197, v197
    v_rcp_f32 v199, v199
    v_lshlrev_b32 v16, 16, v156
    v_and_b32 v17, 0xffff0000, v156
    v_lshlrev_b32 v18, 16, v157
    v_and_b32 v19, 0xffff0000, v157
    v_lshlrev_b32 v20, 16, v160
    v_and_b32 v21, 0xffff0000, v160
    v_lshlrev_b32 v22, 16, v161
    v_and_b32 v23, 0xffff0000, v161
    v_pk_add_f32 v[24:25], v[16:17], v[192:193] op_sel_hi:[1,0] neg_lo:[0,1] neg_hi:[0,1]
    v_pk_add_f32 v[26:27], v[18:19], v[194:195] op_sel_hi:[1,0] neg_lo:[0,1] neg_hi:[0,1]
    v_pk_add_f32 v[28:29], v[20:21], v[196:197] op_sel_hi:[1,0] neg_lo:[0,1] neg_hi:[0,1]
    v_pk_add_f32 v[30:31], v[22:23], v[198:199] op_sel_hi:[1,0] neg_lo:[0,1] neg_hi:[0,1]
    v_cvt_pk_bf16_f32 v172, v24, v25
    v_cvt_pk_bf16_f32 v173, v26, v27
    v_cvt_pk_bf16_f32 v174, v28, v29
    v_cvt_pk_bf16_f32 v175, v30, v31
    v_lshlrev_b32 v24, 16, v172
    v_and_b32 v25, 0xffff0000, v172
    v_lshlrev_b32 v26, 16, v173
    v_and_b32 v27, 0xffff0000, v173
    v_lshlrev_b32 v28, 16, v174
    v_and_b32 v29, 0xffff0000, v174
    v_lshlrev_b32 v30, 16, v175
    v_and_b32 v31, 0xffff0000, v175
    v_pk_mul_f32 v[24:25], v[24:25], v[192:193] op_sel:[0,1] op_sel_hi:[1,1]
    v_pk_mul_f32 v[26:27], v[26:27], v[194:195] op_sel:[0,1] op_sel_hi:[1,1]
    v_pk_mul_f32 v[28:29], v[28:29], v[196:197] op_sel:[0,1] op_sel_hi:[1,1]
    v_pk_mul_f32 v[30:31], v[30:31], v[198:199] op_sel:[0,1] op_sel_hi:[1,1]
    v_cvt_pk_bf16_f32 v172, v24, v25
    v_cvt_pk_bf16_f32 v173, v26, v27
    v_cvt_pk_bf16_f32 v174, v28, v29
    v_cvt_pk_bf16_f32 v175, v30, v31
    v_lshlrev_b32 v24, 16, v172
    v_and_b32 v25, 0xffff0000, v172
    v_lshlrev_b32 v26, 16, v173
    v_and_b32 v27, 0xffff0000, v173
    v_lshlrev_b32 v28, 16, v174
    v_and_b32 v29, 0xffff0000, v174
    v_lshlrev_b32 v30, 16, v175
    v_and_b32 v31, 0xffff0000, v175
    v_cvt_pk_f16_f32 v176, v30, v28
    v_cvt_pk_f16_f32 v177, v26, v24
    ds_write_b64 v4, v[176:177] offset:0
    v_cvt_pk_f16_f32 v178, v31, v29
    v_cvt_pk_f16_f32 v179, v27, v25
    ds_write_b64 v4, v[178:179] offset:49664
    s_waitcnt lgkmcnt(0)
    s_barrier
    s_cmp_lg_u32 s5, 0
    s_cbranch_scc1 K2_NOFD
    v_mov_b32 v236, s100
    v_mov_b32 v237, s101
    s_lshl_b32 s43, s3, 5
    s_add_u32 s43, s43, 0x5a0000
    s_mov_b64 exec, 1
    buffer_store_dwordx2 v[236:237], off, s[12:15], s43 sc1
    s_mov_b64 exec, -1
K2_NOFD:
    ds_read_u16 v231, v230 offset:64
    ds_read_b64 v[116:117], v8 offset:2056
    ds_read_b128 v[118:121], v8 offset:2064
    ds_read_b64 v[122:123], v8 offset:2080
    s_waitcnt lgkmcnt(0)
    v_lshl_or_b32 v231, v231, 16, v231
    v_and_b32 v232, v232, v231
    v_and_b32 v233, v233, v231
    v_and_b32 v234, v234, v231
    v_and_b32 v235, v235, v231
    v_alignbit_b32 v124, v117, v116, 16
    v_alignbit_b32 v125, v118, v117, 16
    v_alignbit_b32 v126, v119, v118, 16
    v_alignbit_b32 v127, v120, v119, 16
    v_alignbit_b32 v128, v121, v120, 16
    v_alignbit_b32 v129, v122, v121, 16
    v_alignbit_b32 v130, v123, v122, 16
    v_pk_add_f16 v132, v125, v118
    v_pk_add_f16 v133, v126, v119
    v_pk_add_f16 v134, v127, v120
    v_pk_add_f16 v135, v128, v121
    v_pk_add_f16 v132, v132, v126
    v_pk_add_f16 v133, v133, v127
    v_pk_add_f16 v134, v134, v128
    v_pk_add_f16 v135, v135, v129
    ds_write_b128 v8, v[132:135] offset:19536
    v_pk_add_f16 v136, v132, v117
    v_pk_add_f16 v137, v133, v118
    v_pk_add_f16 v138, v134, v119
    v_pk_add_f16 v139, v135, v120
    v_pk_add_f16 v136, v136, v119
    v_pk_add_f16 v137, v137, v120
    v_pk_add_f16 v138, v138, v121
    v_pk_add_f16 v139, v139, v122
    ds_write_b128 v8, v[136:139] offset:15376
    v_pk_add_f16 v140, v136, v124
    v_pk_add_f16 v141, v137, v125
    v_pk_add_f16 v142, v138, v126
    v_pk_add_f16 v143, v139, v127
    v_pk_add_f16 v140, v140, v127
    v_pk_add_f16 v141, v141, v128
    v_pk_add_f16 v142, v142, v129
    v_pk_add_f16 v143, v143, v130
    ds_write_b128 v8, v[140:143] offset:27856
    v_pk_add_f16 v144, v140, v116
    v_pk_add_f16 v145, v141, v117
    v_pk_add_f16 v146, v142, v118
    v_pk_add_f16 v147, v143, v119
    v_pk_add_f16 v144, v144, v120
    v_pk_add_f16 v145, v145, v121
    v_pk_add_f16 v146, v146, v122
    v_pk_add_f16 v147, v147, v123
    ds_write_b128 v8, v[144:147] offset:23696
    s_setprio 2
    s_bitcmp1_b32 s5, 0
    s_cbranch_scc1 K2_PB
    s_waitcnt lgkmcnt(0)
    s_barrier
    ds_read_b64 v[32:33], v222 offset:0
    ds_read_b64 v[34:35], v222 offset:8
    ds_read_b128 v[156:159], v223 offset:0
    ds_read_b64 v[36:37], v222 offset:128
    ds_read_b64 v[38:39], v222 offset:136
    ds_read_b128 v[160:163], v223 offset:128
    ds_read_b64 v[40:41], v222 offset:256
    ds_read_b64 v[42:43], v222 offset:264
    ds_read_b128 v[164:167], v223 offset:256
    ds_read_b64 v[44:45], v222 offset:384
    ds_read_b64 v[46:47], v222 offset:392
    ds_read_b128 v[168:171], v223 offset:384
    ds_read_b64 v[48:49], v222 offset:512
    ds_read_b64 v[50:51], v222 offset:520
    ds_read_b128 v[172:175], v223 offset:512
    s_waitcnt lgkmcnt(12)
    v_mfma_f32_16x16x32_f16 v[216:219], v[32:35], v[156:159], 0
    ds_read_b64 v[52:53], v222 offset:640
    s_waitcnt lgkmcnt(10)
    v_mfma_f32_16x16x32_f16 v[216:219], v[36:39], v[160:163], v[216:219]
    ds_read_b64 v[54:55], v222 offset:648
    s_waitcnt lgkmcnt(8)
    v_mfma_f32_16x16x32_f16 v[216:219], v[40:43], v[164:167], v[216:219]
    ds_read_b128 v[156:159], v223 offset:640
    s_waitcnt lgkmcnt(6)
    v_mfma_f32_16x16x32_f16 v[216:219], v[44:47], v[168:171], v[216:219]
    ds_read_b64 v[56:57], v222 offset:768
    s_waitcnt lgkmcnt(4)
    v_mfma_f32_16x16x32_f16 v[216:219], v[48:51], v[172:175], v[216:219]
    ds_read_b64 v[58:59], v222 offset:776
    ds_read_b128 v[160:163], v223 offset:768
    v_mfma_f32_16x16x32_f16 v[212:215], v[32:35], v[172:175], 0
    ds_read_b64 v[60:61], v222 offset:896
    s_waitcnt lgkmcnt(4)
    v_mfma_f32_16x16x32_f16 v[216:219], v[52:55], v[156:159], v[216:219]
    ds_read_b64 v[62:63], v222 offset:904
    ds_read_b128 v[164:167], v223 offset:896
    v_mfma_f32_16x16x32_f16 v[212:215], v[36:39], v[156:159], v[212:215]
    ds_read_b64 v[64:65], v222 offset:1024
    s_waitcnt lgkmcnt(4)
    v_mfma_f32_16x16x32_f16 v[216:219], v[56:59], v[160:163], v[216:219]
    ds_read_b64 v[66:67], v222 offset:1032
    ds_read_b128 v[156:159], v223 offset:1024
    v_mfma_f32_16x16x32_f16 v[212:215], v[40:43], v[160:163], v[212:215]
    ds_read_b128 v[160:163], v223 offset:1152
    s_waitcnt lgkmcnt(4)
    v_mfma_f32_16x16x32_f16 v[216:219], v[60:63], v[164:167], v[216:219]
    ds_read_b128 v[168:171], v223 offset:1280
    v_mfma_f32_16x16x32_f16 v[212:215], v[44:47], v[164:167], v[212:215]
    ds_read_b128 v[164:167], v223 offset:1408
    s_waitcnt lgkmcnt(3)
    v_mfma_f32_16x16x32_f16 v[216:219], v[64:67], v[156:159], v[216:219]
    ds_read_b128 v[172:175], v223 offset:1536
    v_mfma_f32_16x16x32_f16 v[212:215], v[48:51], v[156:159], v[212:215]
    ds_read_b64_tr_b16 v[116:117], v227 offset:2824
    v_mfma_f32_16x16x32_f16 v[208:211], v[32:35], v[156:159], 0
    ds_read_b64_tr_b16 v[118:119], v227 offset:2568
    s_waitcnt lgkmcnt(4)
    v_mfma_f32_16x16x32_f16 v[212:215], v[52:55], v[160:163], v[212:215]
    ds_read_b128 v[156:159], v223 offset:1664
    v_mfma_f32_16x16x32_f16 v[208:211], v[36:39], v[160:163], v[208:211]
    ds_read_b128 v[160:163], v223 offset:1792
    v_mfma_f32_16x16x32_f16 v[212:215], v[56:59], v[168:171], v[212:215]
    ds_read_b64 v[72:73], v224 offset:128
    v_mfma_f32_16x16x32_f16 v[208:211], v[40:43], v[168:171], v[208:211]
    ds_read_b64 v[74:75], v224 offset:160
    s_waitcnt lgkmcnt(6)
    v_mfma_f32_16x16x32_f16 v[212:215], v[60:63], v[164:167], v[212:215]
    ds_read_b128 v[168:171], v223 offset:1920
    v_mfma_f32_16x16x32_f16 v[208:211], v[44:47], v[164:167], v[208:211]
    ds_read_b128 v[164:167], v223 offset:2048
    v_mfma_f32_16x16x32_f16 v[212:215], v[64:67], v[172:175], v[212:215]
    ds_read_b64 v[76:77], v224 offset:64
    v_mfma_f32_16x16x32_f16 v[208:211], v[48:51], v[172:175], v[208:211]
    ds_read_b64 v[78:79], v224 offset:96
    v_mfma_f32_16x16x32_f16 v[204:207], v[32:35], v[172:175], 0
    ds_read_b64 v[80:81], v224 offset:0
    s_waitcnt lgkmcnt(4)
    v_mfma_f32_16x16x32_f16 v[208:211], v[52:55], v[156:159], v[208:211]
    ds_read_b64 v[82:83], v224 offset:32
    v_pk_mul_f32 v[24:25], v[24:25], s[46:47]
    v_mfma_f32_16x16x32_f16 v[204:207], v[36:39], v[156:159], v[204:207]
    ds_read_b128 v[156:159], v223 offset:2176
    v_pk_mul_f32 v[26:27], v[26:27], s[46:47]
    v_mfma_f32_16x16x32_f16 v[208:211], v[56:59], v[160:163], v[208:211]
    ds_read_b128 v[172:175], v223 offset:2304
    v_pk_mul_f32 v[28:29], v[28:29], s[46:47]
    v_mfma_f32_16x16x32_f16 v[204:207], v[40:43], v[160:163], v[204:207]
    ds_read_b64_tr_b16 v[120:121], v227 offset:2312
    v_pk_mul_f32 v[30:31], v[30:31], s[46:47]
    v_mfma_f32_16x16x32_f16 v[208:211], v[60:63], v[168:171], v[208:211]
    ds_read_b64_tr_b16 v[122:123], v227 offset:2056
    v_cvt_pk_bf16_f32 v68, v24, v25
    v_mfma_f32_16x16x32_f16 v[204:207], v[44:47], v[168:171], v[204:207]
    ds_read_b128 v[160:163], v223 offset:2432
    v_cvt_pk_bf16_f32 v69, v26, v27
    s_waitcnt lgkmcnt(4)
    v_mfma_f32_16x16x32_f16 v[216:219], v[232:235], v[164:167], v[216:219]
    ds_read_b128 v[168:171], v223 offset:2560
    v_cvt_pk_bf16_f32 v70, v28, v29
    v_mfma_f32_16x16x32_f16 v[208:211], v[64:67], v[164:167], v[208:211]
    ds_read_b64_tr_b16 v[124:125], v227 offset:1800
    v_cvt_pk_bf16_f32 v71, v30, v31
    v_mfma_f32_16x16x32_f16 v[204:207], v[48:51], v[164:167], v[204:207]
    ds_read_b64_tr_b16 v[126:127], v227 offset:1544
    v_lshlrev_b32 v24, 16, v68
    v_mfma_f32_16x16x32_f16 v[200:203], v[32:35], v[164:167], 0
    ds_read_b64_tr_b16 v[128:129], v227 offset:1288
    v_and_b32 v25, 0xffff0000, v68
    v_mfma_f32_16x16x32_f16 v[204:207], v[52:55], v[156:159], v[204:207]
    ds_read_b64_tr_b16 v[130:131], v227 offset:1032
    v_lshlrev_b32 v26, 16, v69
    v_mfma_f32_16x16x32_f16 v[200:203], v[36:39], v[156:159], v[200:203]
    ds_read_b128 v[156:159], v223 offset:2688
    v_and_b32 v27, 0xffff0000, v69
    s_waitcnt lgkmcnt(5)
    v_mfma_f32_16x16x32_f16 v[204:207], v[56:59], v[172:175], v[204:207]
    ds_read_b128 v[164:167], v223 offset:2816
    v_lshlrev_b32 v28, 16, v70
    v_mfma_f32_16x16x32_f16 v[200:203], v[40:43], v[172:175], v[200:203]
    ds_read_b64_tr_b16 v[132:133], v227 offset:776
    v_and_b32 v29, 0xffff0000, v70
    v_mfma_f32_16x16x32_f16 v[204:207], v[60:63], v[160:163], v[204:207]
    ds_read_b64_tr_b16 v[134:135], v227 offset:520
    v_lshlrev_b32 v30, 16, v71
    v_mfma_f32_16x16x32_f16 v[200:203], v[44:47], v[160:163], v[200:203]
    ds_read_b128 v[160:163], v223 offset:2944
    v_and_b32 v31, 0xffff0000, v71
    v_mfma_f32_16x16x32_f16 v[212:215], v[232:235], v[168:171], v[212:215]
    ds_read_b128 v[172:175], v223 offset:3072
    v_mfma_f32_16x16x32_f16 v[204:207], v[64:67], v[168:171], v[204:207]
    ds_read_b64_tr_b16 v[136:137], v227 offset:264
    v_mfma_f32_16x16x32_f16 v[200:203], v[48:51], v[168:171], v[200:203]
    ds_read_b64_tr_b16 v[138:139], v227 offset:8
    v_mfma_f32_16x16x32_f16 v[196:199], v[32:35], v[168:171], 0
    s_waitcnt lgkmcnt(3)
    v_mfma_f32_16x16x32_f16 v[200:203], v[52:55], v[156:159], v[200:203]
    ds_read_b128 v[168:171], v223 offset:3200
    v_mfma_f32_16x16x32_f16 v[196:199], v[36:39], v[156:159], v[196:199]
    v_mfma_f32_16x16x32_f16 v[200:203], v[56:59], v[164:167], v[200:203]
    ds_read_b128 v[156:159], v223 offset:3328
    v_mfma_f32_16x16x32_f16 v[196:199], v[40:43], v[164:167], v[196:199]
    v_mfma_f32_16x16x32_f16 v[200:203], v[60:63], v[160:163], v[200:203]
    ds_read_b128 v[164:167], v223 offset:3456
    v_mfma_f32_16x16x32_f16 v[196:199], v[44:47], v[160:163], v[196:199]
    s_waitcnt lgkmcnt(2)
    v_mfma_f32_16x16x32_f16 v[208:211], v[232:235], v[172:175], v[208:211]
    ds_read_b128 v[160:163], v223 offset:3584
    v_mfma_f32_16x16x32_f16 v[200:203], v[64:67], v[172:175], v[200:203]
    v_mfma_f32_16x16x32_f16 v[196:199], v[48:51], v[172:175], v[196:199]
    v_mfma_f32_16x16x32_f16 v[192:195], v[32:35], v[172:175], 0
    v_mfma_f32_16x16x32_f16 v[196:199], v[52:55], v[168:171], v[196:199]
    ds_read_b128 v[172:175], v223 offset:3712
    v_mfma_f32_16x16x32_f16 v[192:195], v[36:39], v[168:171], v[192:195]
    s_waitcnt lgkmcnt(1)
    v_mfma_f32_16x16x32_f16 v[196:199], v[56:59], v[156:159], v[196:199]
    ds_read_b128 v[168:171], v223 offset:3840
    v_mfma_f32_16x16x32_f16 v[192:195], v[40:43], v[156:159], v[192:195]
    v_mfma_f32_16x16x32_f16 v[196:199], v[60:63], v[164:167], v[196:199]
    ds_read_b128 v[156:159], v223 offset:3968
    v_mfma_f32_16x16x32_f16 v[192:195], v[44:47], v[164:167], v[192:195]
    v_mfma_f32_16x16x32_f16 v[204:207], v[232:235], v[160:163], v[204:207]
    v_mfma_f32_16x16x32_f16 v[196:199], v[64:67], v[160:163], v[196:199]
    v_mfma_f32_16x16x32_f16 v[192:195], v[48:51], v[160:163], v[192:195]
    v_mfma_f32_16x16x32_f16 v[188:191], v[32:35], v[160:163], 0
    s_waitcnt lgkmcnt(0)
    v_mfma_f32_16x16x32_f16 v[192:195], v[52:55], v[172:175], v[192:195]
    v_mfma_f32_16x16x32_f16 v[188:191], v[36:39], v[172:175], v[188:191]
    v_mfma_f32_16x16x32_f16 v[192:195], v[56:59], v[168:171], v[192:195]
    v_mfma_f32_16x16x32_f16 v[188:191], v[40:43], v[168:171], v[188:191]
    v_mfma_f32_16x16x32_f16 v[192:195], v[60:63], v[156:159], v[192:195]
    v_mfma_f32_16x16x32_f16 v[188:191], v[44:47], v[156:159], v[188:191]
    v_mfma_f32_16x16x32_f16 v[196:199], v[116:119], v[72:75], v[196:199]
    v_mfma_f32_16x16x32_f16 v[200:203], v[116:119], v[76:79], v[200:203]
    v_mfma_f32_16x16x32_f16 v[204:207], v[116:119], v[80:83], v[204:207]
    ds_write_b128 v229, v[192:195] offset:6144
    v_mfma_f32_16x16x32_f16 v[200:203], v[120:123], v[72:75], v[200:203]
    ds_write_b128 v229, v[188:191] offset:7168
    v_mfma_f32_16x16x32_f16 v[204:207], v[120:123], v[76:79], v[204:207]
    ds_write_b128 v229, v[196:199] offset:5120
    v_mfma_f32_16x16x32_f16 v[208:211], v[120:123], v[80:83], v[208:211]
    v_mfma_f32_16x16x32_f16 v[204:207], v[124:127], v[72:75], v[204:207]
    v_mfma_f32_16x16x32_f16 v[208:211], v[124:127], v[76:79], v[208:211]
    ds_write_b128 v229, v[200:203] offset:4096
    v_mfma_f32_16x16x32_f16 v[212:215], v[124:127], v[80:83], v[212:215]
    v_mfma_f32_16x16x32_f16 v[208:211], v[128:131], v[72:75], v[208:211]
    v_mfma_f32_16x16x32_f16 v[212:215], v[128:131], v[76:79], v[212:215]
    ds_write_b128 v229, v[204:207] offset:3072
    v_mfma_f32_16x16x32_f16 v[216:219], v[128:131], v[80:83], v[216:219]
    v_mfma_f32_16x16x32_f16 v[212:215], v[132:135], v[72:75], v[212:215]
    v_mfma_f32_16x16x32_f16 v[216:219], v[132:135], v[76:79], v[216:219]
    ds_write_b128 v229, v[208:211] offset:2048
    v_mfma_f32_16x16x32_f16 v[216:219], v[136:139], v[72:75], v[216:219]
    s_nop 7
    ds_write_b128 v229, v[212:215] offset:1024
    ds_write_b128 v229, v[216:219] offset:0
    s_branch K2_EPI
K2_PB:
    s_waitcnt lgkmcnt(0)
    s_barrier
    ds_read_b64 v[32:33], v222 offset:0
    ds_read_b64 v[34:35], v222 offset:8
    ds_read_b128 v[156:159], v223 offset:64
    ds_read_b64 v[36:37], v222 offset:128
    ds_read_b64 v[38:39], v222 offset:136
    ds_read_b128 v[160:163], v223 offset:192
    ds_read_b64 v[40:41], v222 offset:256
    ds_read_b64 v[42:43], v222 offset:264
    ds_read_b128 v[164:167], v223 offset:320
    ds_read_b64 v[44:45], v222 offset:384
    ds_read_b64 v[46:47], v222 offset:392
    ds_read_b128 v[168:171], v223 offset:448
    ds_read_b64 v[48:49], v222 offset:512
    ds_read_b64 v[50:51], v222 offset:520
    ds_read_b128 v[172:175], v223 offset:576
    s_waitcnt lgkmcnt(12)
    v_mfma_f32_16x16x32_f16 v[216:219], v[32:35], v[156:159], 0
    ds_read_b64 v[52:53], v222 offset:640
    s_waitcnt lgkmcnt(10)
    v_mfma_f32_16x16x32_f16 v[216:219], v[36:39], v[160:163], v[216:219]
    ds_read_b64 v[54:55], v222 offset:648
    s_waitcnt lgkmcnt(8)
    v_mfma_f32_16x16x32_f16 v[216:219], v[40:43], v[164:167], v[216:219]
    ds_read_b128 v[156:159], v223 offset:704
    s_waitcnt lgkmcnt(6)
    v_mfma_f32_16x16x32_f16 v[216:219], v[44:47], v[168:171], v[216:219]
    ds_read_b64 v[56:57], v222 offset:768
    s_waitcnt lgkmcnt(4)
    v_mfma_f32_16x16x32_f16 v[216:219], v[48:51], v[172:175], v[216:219]
    ds_read_b64 v[58:59], v222 offset:776
    ds_read_b128 v[160:163], v223 offset:832
    v_mfma_f32_16x16x32_f16 v[212:215], v[32:35], v[172:175], 0
    ds_read_b64 v[60:61], v222 offset:896
    s_waitcnt lgkmcnt(4)
    v_mfma_f32_16x16x32_f16 v[216:219], v[52:55], v[156:159], v[216:219]
    ds_read_b64 v[62:63], v222 offset:904
    ds_read_b128 v[164:167], v223 offset:960
    v_mfma_f32_16x16x32_f16 v[212:215], v[36:39], v[156:159], v[212:215]
    ds_read_b128 v[156:159], v223 offset:1088
    s_waitcnt lgkmcnt(4)
    v_mfma_f32_16x16x32_f16 v[216:219], v[56:59], v[160:163], v[216:219]
    ds_read_b128 v[168:171], v223 offset:1216
    v_mfma_f32_16x16x32_f16 v[212:215], v[40:43], v[160:163], v[212:215]
    ds_read_b128 v[160:163], v223 offset:1344
    s_waitcnt lgkmcnt(3)
    v_mfma_f32_16x16x32_f16 v[216:219], v[60:63], v[164:167], v[216:219]
    ds_read_b128 v[172:175], v223 offset:1472
    v_mfma_f32_16x16x32_f16 v[212:215], v[44:47], v[164:167], v[212:215]
    ds_read_b128 v[164:167], v223 offset:1600
    s_waitcnt lgkmcnt(4)
    v_mfma_f32_16x16x32_f16 v[212:215], v[48:51], v[156:159], v[212:215]
    ds_read_b128 v[176:179], v223 offset:1728
    v_mfma_f32_16x16x32_f16 v[208:211], v[32:35], v[156:159], 0
    ds_read_b64_tr_b16 v[116:117], v228 offset:1552
    s_waitcnt lgkmcnt(4)
    v_mfma_f32_16x16x32_f16 v[212:215], v[52:55], v[168:171], v[212:215]
    ds_read_b64_tr_b16 v[118:119], v228 offset:1040
    v_mfma_f32_16x16x32_f16 v[208:211], v[36:39], v[168:171], v[208:211]
    ds_read_b128 v[156:159], v223 offset:1856
    v_mfma_f32_16x16x32_f16 v[212:215], v[56:59], v[160:163], v[212:215]
    ds_read_b128 v[168:171], v223 offset:1984
    v_mfma_f32_16x16x32_f16 v[208:211], v[40:43], v[160:163], v[208:211]
    ds_read_b64 v[72:73], v226 offset:96
    s_waitcnt lgkmcnt(5)
    v_mfma_f32_16x16x32_f16 v[212:215], v[60:63], v[172:175], v[212:215]
    ds_read_b64 v[74:75], v226 offset:128
    v_mfma_f32_16x16x32_f16 v[208:211], v[44:47], v[172:175], v[208:211]
    ds_read_b128 v[160:163], v223 offset:2112
    v_mfma_f32_16x16x32_f16 v[208:211], v[48:51], v[164:167], v[208:211]
    ds_read_b128 v[172:175], v223 offset:2240
    v_mfma_f32_16x16x32_f16 v[204:207], v[32:35], v[164:167], 0
    ds_read_b64 v[76:77], v226 offset:64
    v_mfma_f32_16x16x32_f16 v[208:211], v[52:55], v[176:179], v[208:211]
    ds_read_b64 v[78:79], v226 offset:96
    v_mfma_f32_16x16x32_f16 v[204:207], v[36:39], v[176:179], v[204:207]
    ds_read_b128 v[164:167], v223 offset:2368
    s_waitcnt lgkmcnt(4)
    v_mfma_f32_16x16x32_f16 v[208:211], v[56:59], v[156:159], v[208:211]
    ds_read_b128 v[176:179], v223 offset:2496
    v_pk_mul_f32 v[24:25], v[24:25], s[46:47]
    v_mfma_f32_16x16x32_f16 v[204:207], v[40:43], v[156:159], v[204:207]
    ds_read_b64 v[80:81], v226 offset:32
    v_pk_mul_f32 v[26:27], v[26:27], s[46:47]
    v_mfma_f32_16x16x32_f16 v[208:211], v[60:63], v[168:171], v[208:211]
    ds_read_b64 v[82:83], v226 offset:64
    v_pk_mul_f32 v[28:29], v[28:29], s[46:47]
    v_mfma_f32_16x16x32_f16 v[204:207], v[44:47], v[168:171], v[204:207]
    ds_read_b128 v[156:159], v223 offset:2624
    v_pk_mul_f32 v[30:31], v[30:31], s[46:47]
    v_mfma_f32_16x16x32_f16 v[204:207], v[48:51], v[160:163], v[204:207]
    ds_read_b128 v[168:171], v223 offset:2752
    v_cvt_pk_bf16_f32 v68, v24, v25
    v_mfma_f32_16x16x32_f16 v[200:203], v[32:35], v[160:163], 0
    ds_read_b64 v[84:85], v226 offset:0
    v_cvt_pk_bf16_f32 v69, v26, v27
    s_waitcnt lgkmcnt(5)
    v_mfma_f32_16x16x32_f16 v[204:207], v[52:55], v[172:175], v[204:207]
    ds_read_b64 v[86:87], v226 offset:32
    v_cvt_pk_bf16_f32 v70, v28, v29
    v_mfma_f32_16x16x32_f16 v[200:203], v[36:39], v[172:175], v[200:203]
    ds_read_b128 v[160:163], v223 offset:2880
    v_cvt_pk_bf16_f32 v71, v30, v31
    v_mfma_f32_16x16x32_f16 v[204:207], v[56:59], v[164:167], v[204:207]
    ds_read_b128 v[172:175], v223 offset:3008
    v_lshlrev_b32 v24, 16, v68
    v_mfma_f32_16x16x32_f16 v[200:203], v[40:43], v[164:167], v[200:203]
    ds_read_b64_tr_b16 v[120:121], v228 offset:528
    v_and_b32 v25, 0xffff0000, v68
    v_mfma_f32_16x16x32_f16 v[204:207], v[60:63], v[176:179], v[204:207]
    ds_read_b64_tr_b16 v[122:123], v228 offset:16
    v_lshlrev_b32 v26, 16, v69
    v_mfma_f32_16x16x32_f16 v[200:203], v[44:47], v[176:179], v[200:203]
    ds_read_b128 v[164:167], v223 offset:3136
    v_and_b32 v27, 0xffff0000, v69
    s_waitcnt lgkmcnt(4)
    v_mfma_f32_16x16x32_f16 v[200:203], v[48:51], v[156:159], v[200:203]
    ds_read_b128 v[176:179], v223 offset:3264
    v_lshlrev_b32 v28, 16, v70
    v_mfma_f32_16x16x32_f16 v[196:199], v[32:35], v[156:159], 0
    ds_read_b64_tr_b16 v[124:125], v228 offset:5696
    v_and_b32 v29, 0xffff0000, v70
    v_mfma_f32_16x16x32_f16 v[200:203], v[52:55], v[168:171], v[200:203]
    ds_read_b64_tr_b16 v[126:127], v228 offset:5184
    v_lshlrev_b32 v30, 16, v71
    v_mfma_f32_16x16x32_f16 v[196:199], v[36:39], v[168:171], v[196:199]
    ds_read_b128 v[156:159], v223 offset:3392
    v_and_b32 v31, 0xffff0000, v71
    v_mfma_f32_16x16x32_f16 v[200:203], v[56:59], v[160:163], v[200:203]
    ds_read_b128 v[168:171], v223 offset:3520
    v_mfma_f32_16x16x32_f16 v[196:199], v[40:43], v[160:163], v[196:199]
    ds_read_b64 v[88:89], v226 offset:1376
    s_waitcnt lgkmcnt(5)
    v_mfma_f32_16x16x32_f16 v[200:203], v[60:63], v[172:175], v[200:203]
    ds_read_b64 v[90:91], v226 offset:1408
    v_mfma_f32_16x16x32_f16 v[196:199], v[44:47], v[172:175], v[196:199]
    ds_read_b128 v[160:163], v223 offset:3648
    v_mfma_f32_16x16x32_f16 v[196:199], v[48:51], v[164:167], v[196:199]
    ds_read_b128 v[172:175], v223 offset:3776
    v_mfma_f32_16x16x32_f16 v[192:195], v[32:35], v[164:167], 0
    ds_read_b64 v[92:93], v226 offset:1344
    v_mfma_f32_16x16x32_f16 v[196:199], v[52:55], v[176:179], v[196:199]
    ds_read_b64 v[94:95], v226 offset:1376
    v_mfma_f32_16x16x32_f16 v[192:195], v[36:39], v[176:179], v[192:195]
    ds_read_b128 v[164:167], v223 offset:3904
    s_waitcnt lgkmcnt(4)
    v_mfma_f32_16x16x32_f16 v[196:199], v[56:59], v[156:159], v[196:199]
    ds_read_b128 v[176:179], v223 offset:4032
    v_mfma_f32_16x16x32_f16 v[192:195], v[40:43], v[156:159], v[192:195]
    ds_read_b64 v[96:97], v226 offset:1312
    v_mfma_f32_16x16x32_f16 v[196:199], v[60:63], v[168:171], v[196:199]
    ds_read_b64 v[98:99], v226 offset:1344
    v_mfma_f32_16x16x32_f16 v[192:195], v[44:47], v[168:171], v[192:195]
    ds_read_b64 v[100:101], v226 offset:1280
    v_mfma_f32_16x16x32_f16 v[192:195], v[48:51], v[160:163], v[192:195]
    ds_read_b64 v[102:103], v226 offset:1312
    v_mfma_f32_16x16x32_f16 v[188:191], v[32:35], v[160:163], 0
    ds_read_b64_tr_b16 v[128:129], v228 offset:4672
    s_waitcnt lgkmcnt(5)
    v_mfma_f32_16x16x32_f16 v[192:195], v[52:55], v[172:175], v[192:195]
    ds_read_b64_tr_b16 v[130:131], v228 offset:4160
    v_mfma_f32_16x16x32_f16 v[188:191], v[36:39], v[172:175], v[188:191]
    ds_read_b64_tr_b16 v[132:133], v227 offset:6976
    v_mfma_f32_16x16x32_f16 v[192:195], v[56:59], v[164:167], v[192:195]
    ds_read_b64_tr_b16 v[134:135], v227 offset:6720
    v_mfma_f32_16x16x32_f16 v[188:191], v[40:43], v[164:167], v[188:191]
    ds_read_b64 v[104:105], v225 offset:128
    v_mfma_f32_16x16x32_f16 v[192:195], v[60:63], v[176:179], v[192:195]
    ds_read_b64 v[106:107], v225 offset:160
    v_mfma_f32_16x16x32_f16 v[188:191], v[44:47], v[176:179], v[188:191]
    ds_read_b64 v[108:109], v225 offset:64
    v_mfma_f32_16x16x32_f16 v[204:207], v[116:119], v[72:75], v[204:207]
    ds_read_b64 v[110:111], v225 offset:96
    v_mfma_f32_16x16x32_f16 v[208:211], v[116:119], v[76:79], v[208:211]
    ds_read_b64 v[112:113], v225 offset:0
    v_mfma_f32_16x16x32_f16 v[212:215], v[116:119], v[80:83], v[212:215]
    ds_read_b64 v[114:115], v225 offset:32
    ds_write_b128 v229, v[192:195] offset:6144
    v_mfma_f32_16x16x32_f16 v[216:219], v[116:119], v[84:87], v[216:219]
    ds_read_b64_tr_b16 v[116:117], v227 offset:6464
    ds_write_b128 v229, v[188:191] offset:7168
    v_mfma_f32_16x16x32_f16 v[212:215], v[120:123], v[72:75], v[212:215]
    ds_read_b64_tr_b16 v[118:119], v227 offset:6208
    v_mfma_f32_16x16x32_f16 v[216:219], v[120:123], v[76:79], v[216:219]
    ds_read_b64_tr_b16 v[120:121], v227 offset:5952
    v_mfma_f32_16x16x32_f16 v[204:207], v[124:127], v[88:91], v[204:207]
    ds_read_b64_tr_b16 v[122:123], v227 offset:5696
    v_mfma_f32_16x16x32_f16 v[208:211], v[124:127], v[92:95], v[208:211]
    ds_read_b64_tr_b16 v[136:137], v227 offset:5440
    s_waitcnt lgkmcnt(9)
    v_mfma_f32_16x16x32_f16 v[212:215], v[124:127], v[96:99], v[212:215]
    ds_read_b64_tr_b16 v[138:139], v227 offset:5184
    v_mfma_f32_16x16x32_f16 v[216:219], v[124:127], v[100:103], v[216:219]
    ds_read_b64_tr_b16 v[124:125], v227 offset:4928
    v_mfma_f32_16x16x32_f16 v[212:215], v[128:131], v[88:91], v[212:215]
    ds_read_b64_tr_b16 v[126:127], v227 offset:4672
    v_mfma_f32_16x16x32_f16 v[216:219], v[128:131], v[92:95], v[216:219]
    ds_read_b64_tr_b16 v[128:129], v227 offset:4416
    v_mfma_f32_16x16x32_f16 v[196:199], v[132:135], v[104:107], v[196:199]
    ds_read_b64_tr_b16 v[130:131], v227 offset:4160
    v_mfma_f32_16x16x32_f16 v[200:203], v[132:135], v[108:111], v[200:203]
    s_waitcnt lgkmcnt(6)
    v_mfma_f32_16x16x32_f16 v[204:207], v[132:135], v[112:115], v[204:207]
    v_mfma_f32_16x16x32_f16 v[200:203], v[116:119], v[104:107], v[200:203]
    v_mfma_f32_16x16x32_f16 v[204:207], v[116:119], v[108:111], v[204:207]
    ds_write_b128 v229, v[196:199] offset:5120
    v_mfma_f32_16x16x32_f16 v[208:211], v[116:119], v[112:115], v[208:211]
    v_mfma_f32_16x16x32_f16 v[204:207], v[120:123], v[104:107], v[204:207]
    v_mfma_f32_16x16x32_f16 v[208:211], v[120:123], v[108:111], v[208:211]
    ds_write_b128 v229, v[200:203] offset:4096
    v_mfma_f32_16x16x32_f16 v[212:215], v[120:123], v[112:115], v[212:215]
    s_waitcnt lgkmcnt(2)
    v_mfma_f32_16x16x32_f16 v[208:211], v[136:139], v[104:107], v[208:211]
    v_mfma_f32_16x16x32_f16 v[212:215], v[136:139], v[108:111], v[212:215]
    ds_write_b128 v229, v[204:207] offset:3072
    v_mfma_f32_16x16x32_f16 v[216:219], v[136:139], v[112:115], v[216:219]
    v_mfma_f32_16x16x32_f16 v[212:215], v[124:127], v[104:107], v[212:215]
    v_mfma_f32_16x16x32_f16 v[216:219], v[124:127], v[108:111], v[216:219]
    ds_write_b128 v229, v[208:211] offset:2048
    v_mfma_f32_16x16x32_f16 v[216:219], v[128:131], v[104:107], v[216:219]
    s_nop 7
    ds_write_b128 v229, v[212:215] offset:1024
    ds_write_b128 v229, v[216:219] offset:0
    s_branch K2_EPI
K2_HELP:
    s_cmp_lt_u32 s70, 4
    s_cbranch_scc0 K2_LW
    s_waitcnt vmcnt(1)
K2_LW:
    s_mov_b32 s58, 0
    s_waitcnt vmcnt(5)
K2_MSB:
    v_cmp_ne_u64 vcc, s[100:101], v[166:167]
    v_cmp_ne_u64 s[56:57], s[100:101], v[170:171]
    v_cmp_ne_u64 s[54:55], s[100:101], v[158:159]
    v_cmp_ne_u64 s[42:43], s[100:101], v[162:163]
    s_add_u32 s58, s58, 1
    s_or_b64 s[56:57], s[56:57], s[54:55]
    s_or_b64 vcc, vcc, s[42:43]
    s_or_b64 vcc, vcc, s[56:57]
    s_cbranch_scc0 K2_MSOKB
    s_cmp_gt_u32 s58, 131072
    s_cbranch_scc1 K2_MSOKB
    buffer_load_dwordx4 v[164:167], v3, s[12:15], s44 offen sc1
    buffer_load_dwordx4 v[168:171], v3, s[12:15], s45 offen sc1
    buffer_load_dwordx4 v[156:159], v2, s[12:15], s48 offen sc1
    buffer_load_dwordx4 v[160:163], v2, s[12:15], s48 offen offset:16 sc1
    s_waitcnt vmcnt(0)
    s_branch K2_MSB
K2_MSOKB:
    v_and_b32 v193, 0xffff0000, v164
    v_lshlrev_b32 v192, 16, v164
    v_and_b32 v195, 0xffff0000, v165
    v_lshlrev_b32 v194, 16, v165
    v_and_b32 v197, 0xffff0000, v168
    v_lshlrev_b32 v196, 16, v168
    v_and_b32 v199, 0xffff0000, v169
    v_lshlrev_b32 v198, 16, v169
    v_rcp_f32 v193, v193
    v_rcp_f32 v195, v195
    v_rcp_f32 v197, v197
    v_rcp_f32 v199, v199
    v_lshlrev_b32 v16, 16, v156
    v_and_b32 v17, 0xffff0000, v156
    v_lshlrev_b32 v18, 16, v157
    v_and_b32 v19, 0xffff0000, v157
    v_lshlrev_b32 v20, 16, v160
    v_and_b32 v21, 0xffff0000, v160
    v_lshlrev_b32 v22, 16, v161
    v_and_b32 v23, 0xffff0000, v161
    v_pk_add_f32 v[24:25], v[16:17], v[192:193] op_sel_hi:[1,0] neg_lo:[0,1] neg_hi:[0,1]
    v_pk_add_f32 v[26:27], v[18:19], v[194:195] op_sel_hi:[1,0] neg_lo:[0,1] neg_hi:[0,1]
    v_pk_add_f32 v[28:29], v[20:21], v[196:197] op_sel_hi:[1,0] neg_lo:[0,1] neg_hi:[0,1]
    v_pk_add_f32 v[30:31], v[22:23], v[198:199] op_sel_hi:[1,0] neg_lo:[0,1] neg_hi:[0,1]
    v_cvt_pk_bf16_f32 v172, v24, v25
    v_cvt_pk_bf16_f32 v173, v26, v27
    v_cvt_pk_bf16_f32 v174, v28, v29
    v_cvt_pk_bf16_f32 v175, v30, v31
    v_lshlrev_b32 v24, 16, v172
    v_and_b32 v25, 0xffff0000, v172
    v_lshlrev_b32 v26, 16, v173
    v_and_b32 v27, 0xffff0000, v173
    v_lshlrev_b32 v28, 16, v174
    v_and_b32 v29, 0xffff0000, v174
    v_lshlrev_b32 v30, 16, v175
    v_and_b32 v31, 0xffff0000, v175
    v_pk_mul_f32 v[24:25], v[24:25], v[192:193] op_sel:[0,1] op_sel_hi:[1,1]
    v_pk_mul_f32 v[26:27], v[26:27], v[194:195] op_sel:[0,1] op_sel_hi:[1,1]
    v_pk_mul_f32 v[28:29], v[28:29], v[196:197] op_sel:[0,1] op_sel_hi:[1,1]
    v_pk_mul_f32 v[30:31], v[30:31], v[198:199] op_sel:[0,1] op_sel_hi:[1,1]
    v_cvt_pk_bf16_f32 v172, v24, v25
    v_cvt_pk_bf16_f32 v173, v26, v27
    v_cvt_pk_bf16_f32 v174, v28, v29
    v_cvt_pk_bf16_f32 v175, v30, v31
    v_lshlrev_b32 v24, 16, v172
    v_and_b32 v25, 0xffff0000, v172
    v_lshlrev_b32 v26, 16, v173
    v_and_b32 v27, 0xffff0000, v173
    v_lshlrev_b32 v28, 16, v174
    v_and_b32 v29, 0xffff0000, v174
    v_lshlrev_b32 v30, 16, v175
    v_and_b32 v31, 0xffff0000, v175
    v_cvt_pk_f16_f32 v176, v30, v28
    v_cvt_pk_f16_f32 v177, v26, v24
    ds_write_b64 v4, v[176:177] offset:0
    v_cvt_pk_f16_f32 v178, v31, v29
    v_cvt_pk_f16_f32 v179, v27, v25
    ds_write_b64 v4, v[178:179] offset:49664
    s_cmp_lt_u32 s70, 4
    s_cbranch_scc1 K2_WEL
    s_add_u32 m0, s71, 131072
    s_add_u32 s83, s89, 229376
    buffer_load_dwordx4 v237, s[72:75], s83 offen offset:0 lds
    buffer_load_dwordx4 v238, s[72:75], s83 offen offset:1024 lds
    buffer_load_dwordx4 v239, s[72:75], s83 offen offset:2048 lds
    buffer_load_dwordx4 v240, s[72:75], s83 offen offset:3072 lds
K2_WEL:
    s_waitcnt lgkmcnt(0)
    s_barrier
    buffer_load_dwordx4 v[136:139], v132, s[72:75], s84 offen
    buffer_load_dwordx4 v[140:143], v132, s[72:75], s85 offen
    s_mov_b64 exec, 0xf
    ds_write_b128 v234, v[200:203]
    s_mov_b64 exec, -1
    ds_read_b64 v[32:33], v8 offset:8
    ds_read_b128 v[34:37], v8 offset:16
    ds_read_b64 v[38:39], v8 offset:32
    s_waitcnt lgkmcnt(0)
    v_alignbit_b32 v41, v34, v33, 16
    v_alignbit_b32 v42, v35, v34, 16
    v_alignbit_b32 v43, v36, v35, 16
    v_alignbit_b32 v44, v37, v36, 16
    v_alignbit_b32 v45, v38, v37, 16
    v_pk_add_f16 v48, v41, v34
    v_pk_add_f16 v49, v42, v35
    v_pk_add_f16 v50, v43, v36
    v_pk_add_f16 v51, v44, v37
    v_pk_add_f16 v48, v48, v42
    v_pk_add_f16 v49, v49, v43
    v_pk_add_f16 v50, v50, v44
    v_pk_add_f16 v51, v51, v45
    ds_write_b128 v8, v[48:51] offset:17488
    v_pk_add_f16 v52, v48, v33
    v_pk_add_f16 v53, v49, v34
    v_pk_add_f16 v54, v50, v35
    v_pk_add_f16 v55, v51, v36
    v_pk_add_f16 v52, v52, v35
    v_pk_add_f16 v53, v53, v36
    v_pk_add_f16 v54, v54, v37
    v_pk_add_f16 v55, v55, v38
    ds_write_b128 v8, v[52:55] offset:13328
    s_waitcnt lgkmcnt(0)
    s_barrier
    s_cmp_lt_u32 s70, 4
    s_cbranch_scc1 K2_NOW
    s_add_u32 m0, s71, 147456
    s_add_u32 s83, s89, 458752
    buffer_load_dwordx4 v237, s[72:75], s83 offen offset:0 lds
    buffer_load_dwordx4 v238, s[72:75], s83 offen offset:1024 lds
    buffer_load_dwordx4 v239, s[72:75], s83 offen offset:2048 lds
    buffer_load_dwordx4 v240, s[72:75], s83 offen offset:3072 lds
    s_add_u32 s83, s89, 688128
    buffer_load_dwordx4 v[152:155], v237, s[72:75], s83 offen offset:0
    buffer_load_dwordx4 v[156:159], v238, s[72:75], s83 offen offset:1024
    buffer_load_dwordx4 v[160:163], v239, s[72:75], s83 offen offset:2048
    buffer_load_dwordx4 v[164:167], v240, s[72:75], s83 offen offset:3072
    s_add_u32 s83, s89, 917504
    buffer_load_dwordx4 v[168:171], v237, s[72:75], s83 offen offset:0
    buffer_load_dwordx4 v[172:175], v238, s[72:75], s83 offen offset:1024
    buffer_load_dwordx4 v[176:179], v239, s[72:75], s83 offen offset:2048
    buffer_load_dwordx4 v[180:183], v240, s[72:75], s83 offen offset:3072
    s_lshl_b32 s80, s70, 2
    s_add_u32 s80, s80, s51
    s_mul_i32 s80, s80, 5376
    s_add_u32 s80, s80, 1146880
    v_lshlrev_b32 v112, 7, v1
    s_mov_b32 exec_hi, 0x3ff
    buffer_load_dword v250, v112, s[72:75], s80 offen
    s_mov_b64 exec, -1
    s_waitcnt vmcnt(9)
    s_branch K2_CSW
K2_NOW:
    s_lshl_b32 s80, s70, 2
    s_add_u32 s80, s80, s51
    s_mul_i32 s80, s80, 5376
    s_add_u32 s80, s80, 1146880
    v_lshlrev_b32 v112, 7, v1
    s_mov_b32 exec_hi, 0x3ff
    buffer_load_dword v250, v112, s[72:75], s80 offen
    s_mov_b64 exec, -1
    s_waitcnt vmcnt(1)
K2_CSW:
    v_lshlrev_b32 v96, 16, v136
    v_and_b32 v97, 0xffff0000, v136
    v_lshlrev_b32 v104, 16, v140
    v_and_b32 v105, 0xffff0000, v140
    v_lshlrev_b32 v98, 16, v137
    v_and_b32 v99, 0xffff0000, v137
    v_lshlrev_b32 v106, 16, v141
    v_and_b32 v107, 0xffff0000, v141
    v_lshlrev_b32 v100, 16, v138
    v_and_b32 v101, 0xffff0000, v138
    v_lshlrev_b32 v108, 16, v142
    v_and_b32 v109, 0xffff0000, v142
    v_lshlrev_b32 v102, 16, v139
    v_and_b32 v103, 0xffff0000, v139
    v_lshlrev_b32 v110, 16, v143
    v_and_b32 v111, 0xffff0000, v143
    v_add_f32 v96, v96, v104
    v_add_f32 v97, v97, v105
    v_add_f32 v98, v98, v106
    v_add_f32 v99, v99, v107
    v_add_f32 v100, v100, v108
    v_add_f32 v101, v101, v109
    v_add_f32 v102, v102, v110
    v_add_f32 v103, v103, v111
    s_nop 0
    v_permlane32_swap_b32 v96, v100
    v_permlane32_swap_b32 v97, v101
    v_permlane32_swap_b32 v98, v102
    v_permlane32_swap_b32 v99, v103
    v_add_f32 v96, v96, v100
    v_add_f32 v97, v97, v101
    v_add_f32 v98, v98, v102
    v_add_f32 v99, v99, v103
    s_nop 0
    v_permlane16_swap_b32 v96, v98
    v_permlane16_swap_b32 v97, v99
    v_add_f32 v96, v96, v98
    v_add_f32 v97, v97, v99
    s_nop 0
    v_add_f32_dpp v96, v96, v96 row_ror:8 row_mask:0xf bank_mask:0xf
    v_add_f32_dpp v97, v97, v97 row_ror:8 row_mask:0xf bank_mask:0xf
    s_nop 0
    v_add_f32_dpp v96, v96, v96 row_ror:4 row_mask:0xf bank_mask:0xf
    v_add_f32_dpp v97, v97, v97 row_ror:4 row_mask:0xf bank_mask:0xf
    s_nop 0
    v_add_f32_dpp v96, v96, v96 row_ror:2 row_mask:0xf bank_mask:0xf
    v_add_f32_dpp v97, v97, v97 row_ror:2 row_mask:0xf bank_mask:0xf
    v_min_u32 v96, -2, v96
    v_min_u32 v97, -2, v97
    s_cmp_ge_u32 s70, 28
    s_cbranch_scc1 K2_NOCS
    s_mov_b32 exec_lo, 0x00030003
    s_mov_b32 exec_hi, 0x00030003
    buffer_store_dwordx2 v[96:97], v235, s[12:15], s52 offen sc1
    s_mov_b64 exec, -1
K2_NOCS:
    v_pk_mul_f32 v[24:25], v[24:25], s[46:47]
    v_pk_mul_f32 v[26:27], v[26:27], s[46:47]
    v_pk_mul_f32 v[28:29], v[28:29], s[46:47]
    v_pk_mul_f32 v[30:31], v[30:31], s[46:47]
    v_cvt_pk_bf16_f32 v60, v24, v25
    v_cvt_pk_bf16_f32 v61, v26, v27
    v_cvt_pk_bf16_f32 v62, v28, v29
    v_cvt_pk_bf16_f32 v63, v30, v31
    v_lshlrev_b32 v24, 16, v60
    v_and_b32 v25, 0xffff0000, v60
    v_lshlrev_b32 v26, 16, v61
    v_and_b32 v27, 0xffff0000, v61
    v_lshlrev_b32 v28, 16, v62
    v_and_b32 v29, 0xffff0000, v62
    v_lshlrev_b32 v30, 16, v63
    v_and_b32 v31, 0xffff0000, v63
K2_EPI:
    s_waitcnt lgkmcnt(0)
    s_barrier
    ds_read_b64 v[52:53], v12
    ds_read_b128 v[32:35], v14 offset:30208
    ds_read_b128 v[44:47], v14 offset:38400
    ds_read_b128 v[36:39], v13 offset:30208
    ds_read_b128 v[48:51], v13 offset:38400
    s_waitcnt lgkmcnt(2)
    v_pk_add_f32 v[32:33], v[32:33], v[44:45]
    v_pk_add_f32 v[34:35], v[34:35], v[46:47]
    s_waitcnt lgkmcnt(0)
    s_barrier
    v_pk_add_f32 v[36:37], v[36:37], v[48:49]
    v_pk_add_f32 v[38:39], v[38:39], v[50:51]
    v_pk_mul_f32 v[32:33], v[32:33], v[52:53] op_sel_hi:[1,0]
    v_pk_mul_f32 v[34:35], v[34:35], v[52:53] op_sel_hi:[1,0]
    v_pk_mul_f32 v[36:37], v[36:37], v[52:53] op_sel:[0,1] op_sel_hi:[1,1]
    v_pk_mul_f32 v[38:39], v[38:39], v[52:53] op_sel:[0,1] op_sel_hi:[1,1]
    v_cvt_pk_bf16_f32 v40, v35, v39
    v_cvt_pk_bf16_f32 v41, v34, v38
    v_cvt_pk_bf16_f32 v42, v33, v37
    v_cvt_pk_bf16_f32 v43, v32, v36
    v_lshlrev_b32 v32, 16, v40
    v_and_b32 v33, 0xffff0000, v40
    v_lshlrev_b32 v34, 16, v41
    v_and_b32 v35, 0xffff0000, v41
    v_lshlrev_b32 v36, 16, v42
    v_and_b32 v37, 0xffff0000, v42
    v_lshlrev_b32 v38, 16, v43
    v_and_b32 v39, 0xffff0000, v43
    v_pk_add_f32 v[32:33], v[32:33], v[24:25]
    v_pk_add_f32 v[34:35], v[34:35], v[26:27]
    v_pk_add_f32 v[36:37], v[36:37], v[28:29]
    v_pk_add_f32 v[38:39], v[38:39], v[30:31]
    v_cvt_pk_bf16_f32 v40, v32, v33
    v_cvt_pk_bf16_f32 v41, v34, v35
    v_cvt_pk_bf16_f32 v42, v36, v37
    v_cvt_pk_bf16_f32 v43, v38, v39
    v_lshlrev_b32 v32, 16, v40
    v_and_b32 v33, 0xffff0000, v40
    v_lshlrev_b32 v34, 16, v41
    v_and_b32 v35, 0xffff0000, v41
    v_lshlrev_b32 v36, 16, v42
    v_and_b32 v37, 0xffff0000, v42
    v_lshlrev_b32 v38, 16, v43
    v_and_b32 v39, 0xffff0000, v43
    v_pk_add_f32 v[32:33], v[32:33], v[16:17]
    v_pk_add_f32 v[34:35], v[34:35], v[18:19]
    v_pk_add_f32 v[36:37], v[36:37], v[20:21]
    v_pk_add_f32 v[38:39], v[38:39], v[22:23]
    v_cvt_pk_bf16_f32 v40, v32, v34
    v_cvt_pk_bf16_f32 v41, v36, v38
    v_cvt_pk_bf16_f32 v42, v33, v35
    v_cvt_pk_bf16_f32 v43, v37, v39
    v_min_u32 v40, -2, v40
    v_min_u32 v41, -2, v41
    v_min_u32 v42, -2, v42
    v_min_u32 v43, -2, v43
    buffer_store_dwordx2 v[40:41], v15, s[12:15], s53 offen sc1
    buffer_store_dwordx2 v[42:43], v15, s[12:15], s53 offen offset:256 sc1
    s_branch K3_ENTRY
K2_END:
    s_endpgm
K3_ENTRY:
    s_and_b32 s7, s2, 7
    s_lshr_b32 s6, s2, 3
    s_lshl_b32 s3, s7, 1
    s_cmp_lt_u32 s6, 4
    s_cbranch_scc1 K3_SPARE
    s_cmp_lt_u32 s5, 4
    s_cbranch_scc1 K3_COMPUTE
    s_sub_u32 s6, s6, 4
    s_sub_u32 s5, s5, 4
    v_lshrrev_b32 v26, 4, v1
    v_lshlrev_b32 v26, 10, v26
    v_and_b32 v27, 15, v1
    v_lshl_add_u32 v26, v27, 6, v26
    v_and_b32 v27, 28, v1
    v_add3_u32 v26, v26, v27, s71
    v_add_u32 v27, 0x10000, v26
    s_mov_b32 s82, 0
    v_lshl_add_u32 v28, v1, 4, s71
    v_add_u32 v29, 0x10000, v28
    v_add_u32 v30, 0x20000, v28
    s_waitcnt vmcnt(2)
    ds_write_b128 v29, v[152:155] offset:16384
    ds_write_b128 v29, v[156:159] offset:17408
    ds_write_b128 v29, v[160:163] offset:18432
    ds_write_b128 v29, v[164:167] offset:19456
    ds_write_b128 v29, v[168:171] offset:32768
    ds_write_b128 v29, v[172:175] offset:33792
    ds_write_b128 v29, v[176:179] offset:34816
    ds_write_b128 v29, v[180:183] offset:35840
    s_lshr_b32 s68, s2, 3
    s_lshr_b32 s66, s68, 3
    s_and_b32 s68, s68, 7
    s_and_b32 s69, s2, 7
    s_lshl2_add_u32 s66, s69, s66
    v_lshrrev_b32 v245, 3, v1
    v_bfe_u32 v246, v1, 4, 1
    v_lshlrev_b32 v246, 2, v246
    v_and_b32 v247, 7, v1
    v_xor_b32 v247, v247, v246
    v_lshlrev_b32 v247, 4, v247
    v_lshl_add_u32 v241, v245, 10, v247
    v_lshl_add_u32 v245, v245, 8, v247
    v_lshlrev_b32 v246, 4, v1
    v_lshlrev_b32 v247, 7, v1
    v_add_u32 v242, 7168, v241
    v_add_u32 v243, 14336, v241
    v_add_u32 v244, 21504, v241
    s_lshr_b32 s61, s5, 1
    s_lshl_b32 s69, s66, 1
    s_add_u32 s61, s61, s69
    s_mul_i32 s61, s61, 114688
    s_and_b32 s69, s5, 1
    s_lshl_b32 s69, s69, 12
    s_add_u32 s61, s61, s69
    s_add_u32 s61, s61, 0x600000
    s_lshl_b32 s62, s5, 12
    s_lshl_b32 s60, s68, 7
    s_lshl_b32 s69, s5, 15
    s_add_u32 s60, s60, s69
    s_lshl_b32 s63, s68, 14
    s_lshr_b32 s69, s66, 1
    s_lshl_b32 s69, s69, 17
    s_add_u32 s63, s63, s69
    s_and_b32 s69, s66, 1
    s_lshl_b32 s69, s69, 7
    s_add_u32 s63, s63, s69
    s_add_u32 s63, s63, s62
    s_add_u32 s63, s63, 0x200000
    s_lshl_b32 s64, s5, 11
    s_lshl_b32 s65, s66, 12
    s_add_u32 s65, s65, 0x560000
    s_mov_b32 s84, s34
    s_mov_b32 s85, s35
    s_mov_b32 s86, 0x1c0000
    s_mov_b32 s87, 0x00020000
    s_add_u32 s69, s60, 524288
    buffer_load_dwordx4 v[96:99], v241, s[84:87], s69 offen offset:0
    buffer_load_dwordx4 v[100:103], v242, s[84:87], s69 offen offset:1024
    buffer_load_dwordx4 v[104:107], v243, s[84:87], s69 offen offset:2048
    buffer_load_dwordx4 v[108:111], v244, s[84:87], s69 offen offset:3072
    s_waitcnt vmcnt(4) lgkmcnt(0)
    s_barrier
    s_add_u32 m0, s71, 0
    s_add_u32 s83, s88, 0
    buffer_load_dwordx4 v236, s[12:15], s83 offen offset:0 sc1 lds
    buffer_load_dwordx4 v236, s[12:15], s83 offen offset:1024 sc1 lds
    buffer_load_dwordx4 v236, s[12:15], s83 offen offset:2048 sc1 lds
    buffer_load_dwordx4 v236, s[12:15], s83 offen offset:3072 sc1 lds
    s_add_u32 m0, s71, 16384
    s_add_u32 s83, s88, 16384
    buffer_load_dwordx4 v236, s[12:15], s83 offen offset:0 sc1 lds
    buffer_load_dwordx4 v236, s[12:15], s83 offen offset:1024 sc1 lds
    buffer_load_dwordx4 v236, s[12:15], s83 offen offset:2048 sc1 lds
    buffer_load_dwordx4 v236, s[12:15], s83 offen offset:3072 sc1 lds
    s_barrier
    s_add_u32 m0, s71, 114688
    s_add_u32 s83, s89, 1146880
    buffer_load_dwordx4 v237, s[72:75], s83 offen offset:0 lds
    buffer_load_dwordx4 v238, s[72:75], s83 offen offset:1024 lds
    buffer_load_dwordx4 v239, s[72:75], s83 offen offset:2048 lds
    buffer_load_dwordx4 v240, s[72:75], s83 offen offset:3072 lds
    s_add_u32 m0, s71, 131072
    s_add_u32 s83, s89, 1376256
    buffer_load_dwordx4 v237, s[72:75], s83 offen offset:0 lds
    buffer_load_dwordx4 v238, s[72:75], s83 offen offset:1024 lds
    buffer_load_dwordx4 v239, s[72:75], s83 offen offset:2048 lds
    buffer_load_dwordx4 v240, s[72:75], s83 offen offset:3072 lds
    s_add_u32 m0, s71, 147456
    s_add_u32 s83, s89, 1605632
    buffer_load_dwordx4 v237, s[72:75], s83 offen offset:0 lds
    buffer_load_dwordx4 v238, s[72:75], s83 offen offset:1024 lds
    buffer_load_dwordx4 v239, s[72:75], s83 offen offset:2048 lds
    buffer_load_dwordx4 v240, s[72:75], s83 offen offset:3072 lds
    s_waitcnt vmcnt(16)
    ds_read_b32 v32, v26 offset:0
    ds_read_b32 v33, v26 offset:32
K3_CHK0:
    s_add_u32 s82, s82, 1
    s_waitcnt lgkmcnt(0)
    v_max_u32 v32, v32, v33
    v_cmp_eq_u32 vcc, -1, v32
    s_cmp_gt_u32 s82, 131072
    s_cbranch_scc1 K3_OK0
    s_cbranch_vccz K3_OK0
    s_add_u32 m0, s71, 0
    s_add_u32 s83, s88, 0
    buffer_load_dwordx4 v236, s[12:15], s83 offen offset:0 sc1 lds
    buffer_load_dwordx4 v236, s[12:15], s83 offen offset:1024 sc1 lds
    buffer_load_dwordx4 v236, s[12:15], s83 offen offset:2048 sc1 lds
    buffer_load_dwordx4 v236, s[12:15], s83 offen offset:3072 sc1 lds
    s_waitcnt vmcnt(0)
    ds_read_b32 v32, v26 offset:0
    ds_read_b32 v33, v26 offset:32
    s_branch K3_CHK0
K3_OK0:
    s_waitcnt vmcnt(28) lgkmcnt(0)
    s_barrier
    s_add_u32 m0, s71, 32768
    s_add_u32 s83, s88, 32768
    buffer_load_dwordx4 v236, s[12:15], s83 offen offset:0 sc1 lds
    buffer_load_dwordx4 v236, s[12:15], s83 offen offset:1024 sc1 lds
    buffer_load_dwordx4 v236, s[12:15], s83 offen offset:2048 sc1 lds
    buffer_load_dwordx4 v236, s[12:15], s83 offen offset:3072 sc1 lds
    s_add_u32 m0, s71, 49152
    s_add_u32 s83, s88, 49152
    buffer_load_dwordx4 v236, s[12:15], s83 offen offset:0 sc1 lds
    buffer_load_dwordx4 v236, s[12:15], s83 offen offset:1024 sc1 lds
    buffer_load_dwordx4 v236, s[12:15], s83 offen offset:2048 sc1 lds
    buffer_load_dwordx4 v236, s[12:15], s83 offen offset:3072 sc1 lds
    s_waitcnt vmcnt(20)
    ds_read_b32 v32, v26 offset:16384
    ds_read_b32 v33, v26 offset:16416
K3_CHK1:
    s_add_u32 s82, s82, 1
    s_waitcnt lgkmcnt(0)
    v_max_u32 v32, v32, v33
    v_cmp_eq_u32 vcc, -1, v32
    s_cmp_gt_u32 s82, 131072
    s_cbranch_scc1 K3_OK1
    s_cbranch_vccz K3_OK1
    s_add_u32 m0, s71, 16384
    s_add_u32 s83, s88, 16384
    buffer_load_dwordx4 v236, s[12:15], s83 offen offset:0 sc1 lds
    buffer_load_dwordx4 v236, s[12:15], s83 offen offset:1024 sc1 lds
    buffer_load_dwordx4 v236, s[12:15], s83 offen offset:2048 sc1 lds
    buffer_load_dwordx4 v236, s[12:15], s83 offen offset:3072 sc1 lds
    s_waitcnt vmcnt(0)
    ds_read_b32 v32, v26 offset:16384
    ds_read_b32 v33, v26 offset:16416
    s_branch K3_CHK1
K3_OK1:
    s_waitcnt vmcnt(35) lgkmcnt(0)
    s_barrier
    s_add_u32 m0, s71, 65536
    s_add_u32 s83, s88, 65536
    buffer_load_dwordx4 v236, s[12:15], s83 offen offset:0 sc1 lds
    buffer_load_dwordx4 v236, s[12:15], s83 offen offset:1024 sc1 lds
    buffer_load_dwordx4 v236, s[12:15], s83 offen offset:2048 sc1 lds
    buffer_load_dwordx4 v236, s[12:15], s83 offen offset:3072 sc1 lds
    s_add_u32 s69, s60, 655360
    buffer_load_dwordx4 v[112:115], v241, s[84:87], s69 offen offset:0
    buffer_load_dwordx4 v[116:119], v242, s[84:87], s69 offen offset:1024
    buffer_load_dwordx4 v[120:123], v243, s[84:87], s69 offen offset:2048
    buffer_load_dwordx4 v[124:127], v244, s[84:87], s69 offen offset:3072
    s_waitcnt vmcnt(12)
    ds_read_b32 v32, v26 offset:32768
    ds_read_b32 v33, v26 offset:32800
K3_CHK2:
    s_add_u32 s82, s82, 1
    s_waitcnt lgkmcnt(0)
    v_max_u32 v32, v32, v33
    v_cmp_eq_u32 vcc, -1, v32
    s_cmp_gt_u32 s82, 131072
    s_cbranch_scc1 K3_OK2
    s_cbranch_vccz K3_OK2
    s_add_u32 m0, s71, 32768
    s_add_u32 s83, s88, 32768
    buffer_load_dwordx4 v236, s[12:15], s83 offen offset:0 sc1 lds
    buffer_load_dwordx4 v236, s[12:15], s83 offen offset:1024 sc1 lds
    buffer_load_dwordx4 v236, s[12:15], s83 offen offset:2048 sc1 lds
    buffer_load_dwordx4 v236, s[12:15], s83 offen offset:3072 sc1 lds
    s_waitcnt vmcnt(0)
    ds_read_b32 v32, v26 offset:32768
    ds_read_b32 v33, v26 offset:32800
    s_branch K3_CHK2
K3_OK2:
    s_waitcnt vmcnt(42) lgkmcnt(0)
    s_barrier
    s_waitcnt vmcnt(8)
    ds_read_b32 v32, v26 offset:49152
    ds_read_b32 v33, v26 offset:49184
    s_add_u32 m0, s71, 0
    s_add_u32 s83, s88, 81920
    buffer_load_dwordx4 v236, s[12:15], s83 offen offset:0 sc1 lds
    buffer_load_dwordx4 v236, s[12:15], s83 offen offset:1024 sc1 lds
    buffer_load_dwordx4 v236, s[12:15], s83 offen offset:2048 sc1 lds
    buffer_load_dwordx4 v236, s[12:15], s83 offen offset:3072 sc1 lds
    s_add_u32 s69, s60, 786432
    buffer_load_dwordx4 v[128:131], v241, s[84:87], s69 offen offset:0
    buffer_load_dwordx4 v[132:135], v242, s[84:87], s69 offen offset:1024
    buffer_load_dwordx4 v[136:139], v243, s[84:87], s69 offen offset:2048
    buffer_load_dwordx4 v[140:143], v244, s[84:87], s69 offen offset:3072
    s_waitcnt vmcnt(16)
K3_CHK3:
    s_add_u32 s82, s82, 1
    s_waitcnt lgkmcnt(0)
    v_max_u32 v32, v32, v33
    v_cmp_eq_u32 vcc, -1, v32
    s_cmp_gt_u32 s82, 131072
    s_cbranch_scc1 K3_OK3
    s_cbranch_vccz K3_OK3
    s_add_u32 m0, s71, 49152
    s_add_u32 s83, s88, 49152
    buffer_load_dwordx4 v236, s[12:15], s83 offen offset:0 sc1 lds
    buffer_load_dwordx4 v236, s[12:15], s83 offen offset:1024 sc1 lds
    buffer_load_dwordx4 v236, s[12:15], s83 offen offset:2048 sc1 lds
    buffer_load_dwordx4 v236, s[12:15], s83 offen offset:3072 sc1 lds
    s_waitcnt vmcnt(0)
    ds_read_b32 v32, v26 offset:49152
    ds_read_b32 v33, v26 offset:49184
    s_branch K3_CHK3
K3_OK3:
    s_waitcnt vmcnt(49) lgkmcnt(0)
    s_barrier
    s_waitcnt vmcnt(12)
    ds_read_b32 v32, v27 offset:0
    ds_read_b32 v33, v27 offset:32
    s_add_u32 s69, s60, 917504
    buffer_load_dwordx4 v[144:147], v241, s[84:87], s69 offen offset:0
    buffer_load_dwordx4 v[148:151], v242, s[84:87], s69 offen offset:1024
    buffer_load_dwordx4 v[152:155], v243, s[84:87], s69 offen offset:2048
    buffer_load_dwordx4 v[156:159], v244, s[84:87], s69 offen offset:3072
    s_add_u32 s69, s60, 1048576
    buffer_load_dwordx4 v[160:163], v241, s[84:87], s69 offen offset:0
    buffer_load_dwordx4 v[164:167], v242, s[84:87], s69 offen offset:1024
    buffer_load_dwordx4 v[168:171], v243, s[84:87], s69 offen offset:2048
    buffer_load_dwordx4 v[172:175], v244, s[84:87], s69 offen offset:3072
    s_waitcnt vmcnt(20)
K3_CHK4:
    s_add_u32 s82, s82, 1
    s_waitcnt lgkmcnt(0)
    v_max_u32 v32, v32, v33
    v_cmp_eq_u32 vcc, -1, v32
    s_cmp_gt_u32 s82, 131072
    s_cbranch_scc1 K3_OK4
    s_cbranch_vccz K3_OK4
    s_add_u32 m0, s71, 65536
    s_add_u32 s83, s88, 65536
    buffer_load_dwordx4 v236, s[12:15], s83 offen offset:0 sc1 lds
    buffer_load_dwordx4 v236, s[12:15], s83 offen offset:1024 sc1 lds
    buffer_load_dwordx4 v236, s[12:15], s83 offen offset:2048 sc1 lds
    buffer_load_dwordx4 v236, s[12:15], s83 offen offset:3072 sc1 lds
    s_waitcnt vmcnt(0)
    ds_read_b32 v32, v27 offset:0
    ds_read_b32 v33, v27 offset:32
    s_branch K3_CHK4
K3_OK4:
    s_waitcnt vmcnt(56) lgkmcnt(0)
    s_barrier
    s_add_u32 m0, s71, 16384
    s_add_u32 s83, s88, 98304
    buffer_load_dwordx4 v236, s[12:15], s83 offen offset:0 sc1 lds
    buffer_load_dwordx4 v236, s[12:15], s83 offen offset:1024 sc1 lds
    buffer_load_dwordx4 v236, s[12:15], s83 offen offset:2048 sc1 lds
    buffer_load_dwordx4 v236, s[12:15], s83 offen offset:3072 sc1 lds
    s_add_u32 s69, s60, 1179648
    buffer_load_dwordx4 v[176:179], v241, s[84:87], s69 offen offset:0
    buffer_load_dwordx4 v[180:183], v242, s[84:87], s69 offen offset:1024
    buffer_load_dwordx4 v[184:187], v243, s[84:87], s69 offen offset:2048
    buffer_load_dwordx4 v[188:191], v244, s[84:87], s69 offen offset:3072
    s_waitcnt vmcnt(20)
    ds_read_b32 v32, v26 offset:0
    ds_read_b32 v33, v26 offset:32
K3_CHK5:
    s_add_u32 s82, s82, 1
    s_waitcnt lgkmcnt(0)
    v_max_u32 v32, v32, v33
    v_cmp_eq_u32 vcc, -1, v32
    s_cmp_gt_u32 s82, 131072
    s_cbranch_scc1 K3_OK5
    s_cbranch_vccz K3_OK5
    s_add_u32 m0, s71, 0
    s_add_u32 s83, s88, 81920
    buffer_load_dwordx4 v236, s[12:15], s83 offen offset:0 sc1 lds
    buffer_load_dwordx4 v236, s[12:15], s83 offen offset:1024 sc1 lds
    buffer_load_dwordx4 v236, s[12:15], s83 offen offset:2048 sc1 lds
    buffer_load_dwordx4 v236, s[12:15], s83 offen offset:3072 sc1 lds
    s_waitcnt vmcnt(0)
    ds_read_b32 v32, v26 offset:0
    ds_read_b32 v33, v26 offset:32
    s_branch K3_CHK5
K3_OK5:
    s_waitcnt vmcnt(48) lgkmcnt(0)
    s_barrier
    s_add_u32 m0, s71, 32768
    s_add_u32 s83, s88, 114688
    buffer_load_dwordx4 v236, s[12:15], s83 offen offset:0 sc1 lds
    buffer_load_dwordx4 v236, s[12:15], s83 offen offset:1024 sc1 lds
    buffer_load_dwordx4 v236, s[12:15], s83 offen offset:2048 sc1 lds
    buffer_load_dwordx4 v236, s[12:15], s83 offen offset:3072 sc1 lds
    s_add_u32 m0, s62, 81920
    s_add_u32 s69, s60, 0
    buffer_load_dwordx4 v241, s[84:87], s69 offen offset:0 lds
    buffer_load_dwordx4 v242, s[84:87], s69 offen offset:1024 lds
    buffer_load_dwordx4 v243, s[84:87], s69 offen offset:2048 lds
    buffer_load_dwordx4 v244, s[84:87], s69 offen offset:3072 lds
    s_waitcnt vmcnt(12)
    ds_read_b32 v32, v26 offset:16384
    ds_read_b32 v33, v26 offset:16416
K3_CHK6:
    s_add_u32 s82, s82, 1
    s_waitcnt lgkmcnt(0)
    v_max_u32 v32, v32, v33
    v_cmp_eq_u32 vcc, -1, v32
    s_cmp_gt_u32 s82, 131072
    s_cbranch_scc1 K3_OK6
    s_cbranch_vccz K3_OK6
    s_add_u32 m0, s71, 16384
    s_add_u32 s83, s88, 98304
    buffer_load_dwordx4 v236, s[12:15], s83 offen offset:0 sc1 lds
    buffer_load_dwordx4 v236, s[12:15], s83 offen offset:1024 sc1 lds
    buffer_load_dwordx4 v236, s[12:15], s83 offen offset:2048 sc1 lds
    buffer_load_dwordx4 v236, s[12:15], s83 offen offset:3072 sc1 lds
    s_waitcnt vmcnt(0)
    ds_read_b32 v32, v26 offset:16384
    ds_read_b32 v33, v26 offset:16416
    s_branch K3_CHK6
K3_OK6:
    s_waitcnt vmcnt(52) lgkmcnt(0)
    s_barrier
    s_add_u32 m0, s62, 98304
    s_add_u32 s69, s60, 131072
    buffer_load_dwordx4 v241, s[84:87], s69 offen offset:0 lds
    buffer_load_dwordx4 v242, s[84:87], s69 offen offset:1024 lds
    buffer_load_dwordx4 v243, s[84:87], s69 offen offset:2048 lds
    buffer_load_dwordx4 v244, s[84:87], s69 offen offset:3072 lds
    s_add_u32 m0, s62, 49152
    s_add_u32 s69, s60, 262144
    buffer_load_dwordx4 v241, s[84:87], s69 offen offset:0 lds
    buffer_load_dwordx4 v242, s[84:87], s69 offen offset:1024 lds
    buffer_load_dwordx4 v243, s[84:87], s69 offen offset:2048 lds
    buffer_load_dwordx4 v244, s[84:87], s69 offen offset:3072 lds
    s_waitcnt vmcnt(12)
    ds_read_b32 v32, v26 offset:32768
    ds_read_b32 v33, v26 offset:32800
K3_CHK7:
    s_add_u32 s82, s82, 1
    s_waitcnt lgkmcnt(0)
    v_max_u32 v32, v32, v33
    v_cmp_eq_u32 vcc, -1, v32
    s_cmp_gt_u32 s82, 131072
    s_cbranch_scc1 K3_OK7
    s_cbranch_vccz K3_OK7
    s_add_u32 m0, s71, 32768
    s_add_u32 s83, s88, 114688
    buffer_load_dwordx4 v236, s[12:15], s83 offen offset:0 sc1 lds
    buffer_load_dwordx4 v236, s[12:15], s83 offen offset:1024 sc1 lds
    buffer_load_dwordx4 v236, s[12:15], s83 offen offset:2048 sc1 lds
    buffer_load_dwordx4 v236, s[12:15], s83 offen offset:3072 sc1 lds
    s_waitcnt vmcnt(0)
    ds_read_b32 v32, v26 offset:32768
    ds_read_b32 v33, v26 offset:32800
    s_branch K3_CHK7
K3_OK7:
    s_waitcnt vmcnt(56) lgkmcnt(0)
    s_barrier
    s_add_u32 m0, s62, 114688
    s_add_u32 s69, s60, 393216
    buffer_load_dwordx4 v241, s[84:87], s69 offen offset:0 lds
    buffer_load_dwordx4 v242, s[84:87], s69 offen offset:1024 lds
    buffer_load_dwordx4 v243, s[84:87], s69 offen offset:2048 lds
    buffer_load_dwordx4 v244, s[84:87], s69 offen offset:3072 lds
    s_mov_b32 s84, s34
    s_mov_b32 s85, s35
    s_mov_b32 s86, 0x1c0000
    s_mov_b32 s87, 0x00020000
    s_lshl_b32 s83, s6, 2
    s_add_u32 s83, s83, s5
    s_mul_i32 s83, s83, 4736
    s_add_u32 s83, s83, 1310720
    s_mov_b32 exec_hi, 0x1f
    v_lshlrev_b32 v24, 7, v1
    buffer_load_dword v25, v24, s[84:87], s83 offen
    s_mov_b64 exec, -1
    s_barrier
    s_barrier
    s_branch K4_LV4
    s_endpgm
K3_SPARE:
    s_and_b32 s82, s5, 3
    s_lshl_b32 s82, s82, 11
    s_add_u32 s82, s82, 0x5a0000
    v_lshlrev_b32 v100, 5, v1
    buffer_load_dwordx2 v[102:103], v100, s[12:15], s82 offen sc1
    v_mov_b32 v241, 0
    v_mov_b32 v242, 0
    v_mov_b32 v243, 0
    v_mov_b32 v244, 0
    v_mov_b32 v245, 0
    v_mov_b32 v246, 0
    v_mov_b32 v247, 0
    s_getpc_b64 s[70:71]
PC_1:
    s_sub_u32 s70, s70, PC_1-sequential_preLN__ssm_conv_s4d__dense_activation_relu__prompt_kernel
    s_subb_u32 s71, s71, 0
    v_lshlrev_b32 v126, 7, v0
    v_min_u32 v126, CODE_END-sequential_preLN__ssm_conv_s4d__dense_activation_relu__prompt_kernel-4, v126
    global_load_dword v250, v126, s[70:71]
    s_lshr_b32 s4, s6, 1
    s_add_u32 s3, s3, s4
    s_and_b32 s4, s6, 1
    s_lshl_b32 s42, s3, 17
    s_add_u32 s42, s42, 0x200000
    s_lshl_b32 s43, s4, 7
    s_add_u32 s42, s42, s43
    s_lshl_b32 s43, s5, 11
    s_add_u32 s42, s42, s43
    v_lshrrev_b32 v4, 3, v1
    v_and_b32 v5, 7, v1
    v_lshlrev_b32 v6, 4, v5
    v_lshl_add_u32 v8, v4, 8, v6
    v_lshlrev_b32 v20, 7, v1
    s_mul_i32 s80, s6, 24
    s_mul_i32 s81, s5, 3
    s_add_u32 s80, s80, s81
    s_add_u32 s80, s80, 0
    s_lshl_b32 s80, s80, 13
    s_lshl_b32 s44, s3, 9
    s_lshl_b32 s45, s4, 8
    s_add_u32 s44, s44, s45
    s_add_u32 s44, s44, 0x548000
    v_min_u32 v22, 128, v20
    v_min_u32 v23, 1920, v20
    s_mul_i32 s45, s6, 7
    s_add_u32 s45, s45, s5
    s_lshl_b32 s45, s45, 11
    s_add_u32 s45, s45, 0x54f800
    s_cmp_eq_u32 s5, 0
    s_cselect_b64 vcc, -1, 0
    s_cselect_b32 s45, s44, s45
    v_cndmask_b32 v22, v23, v22, vcc
    s_waitcnt vmcnt(0)
    s_mov_b32 s83, 0
FD_CS:
    v_cmp_ne_u64 vcc, s[100:101], v[102:103]
    s_add_u32 s83, s83, 1
    s_cbranch_vccz FD_DS
    s_cmp_gt_u32 s83, 131072
    s_cbranch_scc1 FD_DS
    buffer_load_dwordx2 v[102:103], v100, s[12:15], s82 offen sc1
    s_waitcnt vmcnt(0)
    s_branch FD_CS
FD_DS:
    s_barrier
    s_mov_b32 s76, s34
    s_mov_b32 s77, s35
    s_mov_b32 s78, 0x1c0000
    s_mov_b32 s79, 0x00020000
    s_cmp_lt_u32 s5, 4
    s_cbranch_scc1 K3_SPF
    s_sub_u32 s5, s5, 4
    s_lshr_b32 s68, s2, 3
    s_lshr_b32 s66, s68, 3
    s_and_b32 s68, s68, 7
    s_and_b32 s69, s2, 7
    s_lshl2_add_u32 s66, s69, s66
    v_lshrrev_b32 v245, 3, v1
    v_bfe_u32 v246, v1, 4, 1
    v_lshlrev_b32 v246, 2, v246
    v_and_b32 v247, 7, v1
    v_xor_b32 v247, v247, v246
    v_lshlrev_b32 v247, 4, v247
    v_lshl_add_u32 v241, v245, 10, v247
    v_lshl_add_u32 v245, v245, 8, v247
    v_lshlrev_b32 v246, 4, v1
    v_lshlrev_b32 v247, 7, v1
    v_add_u32 v242, 7168, v241
    v_add_u32 v243, 14336, v241
    v_add_u32 v244, 21504, v241
    s_lshr_b32 s61, s5, 1
    s_lshl_b32 s69, s66, 1
    s_add_u32 s61, s61, s69
    s_mul_i32 s61, s61, 114688
    s_and_b32 s69, s5, 1
    s_lshl_b32 s69, s69, 12
    s_add_u32 s61, s61, s69
    s_add_u32 s61, s61, 0x600000
    s_lshl_b32 s62, s5, 12
    s_lshl_b32 s60, s68, 7
    s_lshl_b32 s69, s5, 15
    s_add_u32 s60, s60, s69
    s_lshl_b32 s63, s68, 14
    s_lshr_b32 s69, s66, 1
    s_lshl_b32 s69, s69, 17
    s_add_u32 s63, s63, s69
    s_and_b32 s69, s66, 1
    s_lshl_b32 s69, s69, 7
    s_add_u32 s63, s63, s69
    s_add_u32 s63, s63, s62
    s_add_u32 s63, s63, 0x200000
    s_lshl_b32 s64, s5, 11
    s_lshl_b32 s65, s66, 12
    s_add_u32 s65, s65, 0x560000
    s_mov_b32 s84, s34
    s_mov_b32 s85, s35
    s_mov_b32 s86, 0x1c0000
    s_mov_b32 s87, 0x00020000
    s_add_u32 s69, s60, 524288
    buffer_load_dwordx4 v[96:99], v241, s[84:87], s69 offen offset:0
    buffer_load_dwordx4 v[100:103], v242, s[84:87], s69 offen offset:1024
    buffer_load_dwordx4 v[104:107], v243, s[84:87], s69 offen offset:2048
    buffer_load_dwordx4 v[108:111], v244, s[84:87], s69 offen offset:3072
    s_add_u32 s69, s60, 655360
    buffer_load_dwordx4 v[112:115], v241, s[84:87], s69 offen offset:0
    buffer_load_dwordx4 v[116:119], v242, s[84:87], s69 offen offset:1024
    buffer_load_dwordx4 v[120:123], v243, s[84:87], s69 offen offset:2048
    buffer_load_dwordx4 v[124:127], v244, s[84:87], s69 offen offset:3072
    buffer_load_dwordx4 v[48:51], v8, s[12:15], s42 offen sc1
    s_add_u32 s42, s42, 16384
    buffer_load_dwordx4 v[52:55], v8, s[12:15], s42 offen sc1
    s_add_u32 s42, s42, 16384
    buffer_load_dwordx4 v[56:59], v8, s[12:15], s42 offen sc1
    s_add_u32 s42, s42, 16384
    buffer_load_dwordx4 v[60:63], v8, s[12:15], s42 offen sc1
    s_add_u32 s42, s42, 16384
    buffer_load_dword v250, v22, s[12:15], s45 offen
    buffer_load_dwordx4 v[64:67], v8, s[12:15], s42 offen sc1
    s_add_u32 s42, s42, 16384
    buffer_load_dwordx4 v[68:71], v8, s[12:15], s42 offen sc1
    s_add_u32 s42, s42, 16384
    buffer_load_dwordx4 v[72:75], v8, s[12:15], s42 offen sc1
    s_add_u32 s42, s42, 16384
    buffer_load_dwordx4 v[76:79], v8, s[12:15], s42 offen sc1
    s_add_u32 s69, s60, 786432
    buffer_load_dwordx4 v[128:131], v241, s[84:87], s69 offen offset:0
    buffer_load_dwordx4 v[132:135], v242, s[84:87], s69 offen offset:1024
    buffer_load_dwordx4 v[136:139], v243, s[84:87], s69 offen offset:2048
    buffer_load_dwordx4 v[140:143], v244, s[84:87], s69 offen offset:3072
    s_add_u32 s69, s60, 917504
    buffer_load_dwordx4 v[144:147], v241, s[84:87], s69 offen offset:0
    buffer_load_dwordx4 v[148:151], v242, s[84:87], s69 offen offset:1024
    buffer_load_dwordx4 v[152:155], v243, s[84:87], s69 offen offset:2048
    buffer_load_dwordx4 v[156:159], v244, s[84:87], s69 offen offset:3072
    s_add_u32 s69, s60, 1048576
    buffer_load_dwordx4 v[160:163], v241, s[84:87], s69 offen offset:0
    buffer_load_dwordx4 v[164:167], v242, s[84:87], s69 offen offset:1024
    buffer_load_dwordx4 v[168:171], v243, s[84:87], s69 offen offset:2048
    buffer_load_dwordx4 v[172:175], v244, s[84:87], s69 offen offset:3072
    s_add_u32 m0, s62, 81920
    s_add_u32 s69, s60, 0
    buffer_load_dwordx4 v241, s[84:87], s69 offen offset:0 lds
    buffer_load_dwordx4 v242, s[84:87], s69 offen offset:1024 lds
    buffer_load_dwordx4 v243, s[84:87], s69 offen offset:2048 lds
    buffer_load_dwordx4 v244, s[84:87], s69 offen offset:3072 lds
    s_add_u32 m0, s62, 98304
    s_add_u32 s69, s60, 131072
    buffer_load_dwordx4 v241, s[84:87], s69 offen offset:0 lds
    buffer_load_dwordx4 v242, s[84:87], s69 offen offset:1024 lds
    buffer_load_dwordx4 v243, s[84:87], s69 offen offset:2048 lds
    buffer_load_dwordx4 v244, s[84:87], s69 offen offset:3072 lds
    s_add_u32 s69, s60, 1179648
    buffer_load_dwordx4 v[176:179], v241, s[84:87], s69 offen offset:0
    buffer_load_dwordx4 v[180:183], v242, s[84:87], s69 offen offset:1024
    buffer_load_dwordx4 v[184:187], v243, s[84:87], s69 offen offset:2048
    buffer_load_dwordx4 v[188:191], v244, s[84:87], s69 offen offset:3072
    s_add_u32 m0, s62, 49152
    s_add_u32 s69, s60, 262144
    buffer_load_dwordx4 v241, s[84:87], s69 offen offset:0 lds
    buffer_load_dwordx4 v242, s[84:87], s69 offen offset:1024 lds
    buffer_load_dwordx4 v243, s[84:87], s69 offen offset:2048 lds
    buffer_load_dwordx4 v244, s[84:87], s69 offen offset:3072 lds
    s_add_u32 m0, s62, 114688
    s_add_u32 s69, s60, 393216
    buffer_load_dwordx4 v241, s[84:87], s69 offen offset:0 lds
    buffer_load_dwordx4 v242, s[84:87], s69 offen offset:1024 lds
    buffer_load_dwordx4 v243, s[84:87], s69 offen offset:2048 lds
    buffer_load_dwordx4 v244, s[84:87], s69 offen offset:3072 lds
    s_add_u32 s5, s5, 4
    s_waitcnt vmcnt(32)
    s_branch K3_SPFD
K3_SPF:
    v_lshlrev_b32 v20, 10, v1
    s_lshl_b32 s80, s6, 2
    s_add_u32 s80, s80, s5
    s_lshl_b32 s80, s80, 16
    buffer_load_dword v250, v20, s[76:79], s80 offen offset:384
    s_lshl_b32 s80, s5, 16
    s_lshl_b32 s81, s6, 7
    s_add_u32 s80, s80, s81
    s_add_u32 s80, s80, 512
    buffer_load_dwordx4 v[48:51], v8, s[12:15], s42 offen sc1
    s_add_u32 s42, s42, 16384
    buffer_load_dwordx4 v[52:55], v8, s[12:15], s42 offen sc1
    s_add_u32 s42, s42, 16384
    buffer_load_dwordx4 v[56:59], v8, s[12:15], s42 offen sc1
    s_add_u32 s42, s42, 16384
    buffer_load_dwordx4 v[60:63], v8, s[12:15], s42 offen sc1
    s_add_u32 s42, s42, 16384
    buffer_load_dword v250, v22, s[12:15], s45 offen
    buffer_load_dwordx4 v[64:67], v8, s[12:15], s42 offen sc1
    s_add_u32 s42, s42, 16384
    buffer_load_dwordx4 v[68:71], v8, s[12:15], s42 offen sc1
    s_add_u32 s42, s42, 16384
    buffer_load_dwordx4 v[72:75], v8, s[12:15], s42 offen sc1
    s_add_u32 s42, s42, 16384
    buffer_load_dwordx4 v[76:79], v8, s[12:15], s42 offen sc1
    s_waitcnt vmcnt(0)
K3_SPFD:
    v_mov_b32 v32, 0
    v_mov_b32 v33, 0
    v_mov_b32 v34, 0
    v_mov_b32 v35, 0
    v_mov_b32 v36, 0
    v_mov_b32 v37, 0
    v_mov_b32 v38, 0
    v_mov_b32 v39, 0
    v_mov_b32 v40, 0
    v_mov_b32 v41, 0
    v_mov_b32 v42, 0
    v_mov_b32 v43, 0
    v_mov_b32 v44, 0
    v_mov_b32 v45, 0
    v_mov_b32 v46, 0
    v_mov_b32 v47, 0
    v_lshlrev_b32 v9, 11, v5
    v_lshl_add_u32 v9, v4, 2, v9
    s_lshl_b32 s43, s5, 5
    v_add_u32 v9, s43, v9
    v_lshlrev_b32 v10, 6, v0
    s_mov_b32 s82, 0
    s_waitcnt vmcnt(63)
K3_SCHK:
    v_max3_u32 v80, v48, v49, v50
    v_max3_u32 v80, v80, v51, v52
    v_max3_u32 v80, v80, v53, v54
    v_max3_u32 v80, v80, v55, v56
    v_max3_u32 v80, v80, v57, v58
    v_max3_u32 v80, v80, v59, v60
    v_max3_u32 v80, v80, v61, v62
    v_max3_u32 v80, v80, v63, v64
    v_max3_u32 v80, v80, v65, v66
    v_max3_u32 v80, v80, v67, v68
    v_max3_u32 v80, v80, v69, v70
    v_max3_u32 v80, v80, v71, v72
    v_max3_u32 v80, v80, v73, v74
    v_max3_u32 v80, v80, v75, v76
    v_max3_u32 v80, v80, v77, v78
    v_max_u32 v80, v80, v79
    s_add_u32 s82, s82, 1
    v_cmp_eq_u32 vcc, -1, v80
    s_cmp_gt_u32 s82, 131072
    s_cbranch_scc1 K3_SOK
    s_cbranch_vccz K3_SOK
    s_sub_u32 s83, s42, 114688
    buffer_load_dwordx4 v[48:51], v8, s[12:15], s83 offen sc1
    s_sub_u32 s83, s42, 98304
    buffer_load_dwordx4 v[52:55], v8, s[12:15], s83 offen sc1
    s_sub_u32 s83, s42, 81920
    buffer_load_dwordx4 v[56:59], v8, s[12:15], s83 offen sc1
    s_sub_u32 s83, s42, 65536
    buffer_load_dwordx4 v[60:63], v8, s[12:15], s83 offen sc1
    s_sub_u32 s83, s42, 49152
    buffer_load_dwordx4 v[64:67], v8, s[12:15], s83 offen sc1
    s_sub_u32 s83, s42, 32768
    buffer_load_dwordx4 v[68:71], v8, s[12:15], s83 offen sc1
    s_sub_u32 s83, s42, 16384
    buffer_load_dwordx4 v[72:75], v8, s[12:15], s83 offen sc1
    s_sub_u32 s83, s42, 0
    buffer_load_dwordx4 v[76:79], v8, s[12:15], s83 offen sc1
    s_waitcnt vmcnt(0)
    s_branch K3_SCHK
K3_SOK:
    v_lshlrev_b32 v24, 16, v48
    v_and_b32 v25, 0xffff0000, v48
    v_lshlrev_b32 v26, 16, v49
    v_and_b32 v27, 0xffff0000, v49
    v_lshlrev_b32 v28, 16, v50
    v_and_b32 v29, 0xffff0000, v50
    v_lshlrev_b32 v30, 16, v51
    v_and_b32 v31, 0xffff0000, v51
    v_pk_add_f32 v[32:33], v[32:33], v[24:25]
    v_pk_fma_f32 v[40:41], v[24:25], v[24:25], v[40:41]
    v_pk_add_f32 v[34:35], v[34:35], v[26:27]
    v_pk_fma_f32 v[42:43], v[26:27], v[26:27], v[42:43]
    v_pk_add_f32 v[36:37], v[36:37], v[28:29]
    v_pk_fma_f32 v[44:45], v[28:29], v[28:29], v[44:45]
    v_pk_add_f32 v[38:39], v[38:39], v[30:31]
    v_pk_fma_f32 v[46:47], v[30:31], v[30:31], v[46:47]
    v_lshlrev_b32 v24, 16, v52
    v_and_b32 v25, 0xffff0000, v52
    v_lshlrev_b32 v26, 16, v53
    v_and_b32 v27, 0xffff0000, v53
    v_lshlrev_b32 v28, 16, v54
    v_and_b32 v29, 0xffff0000, v54
    v_lshlrev_b32 v30, 16, v55
    v_and_b32 v31, 0xffff0000, v55
    v_pk_add_f32 v[32:33], v[32:33], v[24:25]
    v_pk_fma_f32 v[40:41], v[24:25], v[24:25], v[40:41]
    v_pk_add_f32 v[34:35], v[34:35], v[26:27]
    v_pk_fma_f32 v[42:43], v[26:27], v[26:27], v[42:43]
    v_pk_add_f32 v[36:37], v[36:37], v[28:29]
    v_pk_fma_f32 v[44:45], v[28:29], v[28:29], v[44:45]
    v_pk_add_f32 v[38:39], v[38:39], v[30:31]
    v_pk_fma_f32 v[46:47], v[30:31], v[30:31], v[46:47]
    v_lshlrev_b32 v24, 16, v56
    v_and_b32 v25, 0xffff0000, v56
    v_lshlrev_b32 v26, 16, v57
    v_and_b32 v27, 0xffff0000, v57
    v_lshlrev_b32 v28, 16, v58
    v_and_b32 v29, 0xffff0000, v58
    v_lshlrev_b32 v30, 16, v59
    v_and_b32 v31, 0xffff0000, v59
    v_pk_add_f32 v[32:33], v[32:33], v[24:25]
    v_pk_fma_f32 v[40:41], v[24:25], v[24:25], v[40:41]
    v_pk_add_f32 v[34:35], v[34:35], v[26:27]
    v_pk_fma_f32 v[42:43], v[26:27], v[26:27], v[42:43]
    v_pk_add_f32 v[36:37], v[36:37], v[28:29]
    v_pk_fma_f32 v[44:45], v[28:29], v[28:29], v[44:45]
    v_pk_add_f32 v[38:39], v[38:39], v[30:31]
    v_pk_fma_f32 v[46:47], v[30:31], v[30:31], v[46:47]
    v_lshlrev_b32 v24, 16, v60
    v_and_b32 v25, 0xffff0000, v60
    v_lshlrev_b32 v26, 16, v61
    v_and_b32 v27, 0xffff0000, v61
    v_lshlrev_b32 v28, 16, v62
    v_and_b32 v29, 0xffff0000, v62
    v_lshlrev_b32 v30, 16, v63
    v_and_b32 v31, 0xffff0000, v63
    v_pk_add_f32 v[32:33], v[32:33], v[24:25]
    v_pk_fma_f32 v[40:41], v[24:25], v[24:25], v[40:41]
    v_pk_add_f32 v[34:35], v[34:35], v[26:27]
    v_pk_fma_f32 v[42:43], v[26:27], v[26:27], v[42:43]
    v_pk_add_f32 v[36:37], v[36:37], v[28:29]
    v_pk_fma_f32 v[44:45], v[28:29], v[28:29], v[44:45]
    v_pk_add_f32 v[38:39], v[38:39], v[30:31]
    v_pk_fma_f32 v[46:47], v[30:31], v[30:31], v[46:47]
    v_lshlrev_b32 v24, 16, v64
    v_and_b32 v25, 0xffff0000, v64
    v_lshlrev_b32 v26, 16, v65
    v_and_b32 v27, 0xffff0000, v65
    v_lshlrev_b32 v28, 16, v66
    v_and_b32 v29, 0xffff0000, v66
    v_lshlrev_b32 v30, 16, v67
    v_and_b32 v31, 0xffff0000, v67
    v_pk_add_f32 v[32:33], v[32:33], v[24:25]
    v_pk_fma_f32 v[40:41], v[24:25], v[24:25], v[40:41]
    v_pk_add_f32 v[34:35], v[34:35], v[26:27]
    v_pk_fma_f32 v[42:43], v[26:27], v[26:27], v[42:43]
    v_pk_add_f32 v[36:37], v[36:37], v[28:29]
    v_pk_fma_f32 v[44:45], v[28:29], v[28:29], v[44:45]
    v_pk_add_f32 v[38:39], v[38:39], v[30:31]
    v_pk_fma_f32 v[46:47], v[30:31], v[30:31], v[46:47]
    v_lshlrev_b32 v24, 16, v68
    v_and_b32 v25, 0xffff0000, v68
    v_lshlrev_b32 v26, 16, v69
    v_and_b32 v27, 0xffff0000, v69
    v_lshlrev_b32 v28, 16, v70
    v_and_b32 v29, 0xffff0000, v70
    v_lshlrev_b32 v30, 16, v71
    v_and_b32 v31, 0xffff0000, v71
    v_pk_add_f32 v[32:33], v[32:33], v[24:25]
    v_pk_fma_f32 v[40:41], v[24:25], v[24:25], v[40:41]
    v_pk_add_f32 v[34:35], v[34:35], v[26:27]
    v_pk_fma_f32 v[42:43], v[26:27], v[26:27], v[42:43]
    v_pk_add_f32 v[36:37], v[36:37], v[28:29]
    v_pk_fma_f32 v[44:45], v[28:29], v[28:29], v[44:45]
    v_pk_add_f32 v[38:39], v[38:39], v[30:31]
    v_pk_fma_f32 v[46:47], v[30:31], v[30:31], v[46:47]
    v_lshlrev_b32 v24, 16, v72
    v_and_b32 v25, 0xffff0000, v72
    v_lshlrev_b32 v26, 16, v73
    v_and_b32 v27, 0xffff0000, v73
    v_lshlrev_b32 v28, 16, v74
    v_and_b32 v29, 0xffff0000, v74
    v_lshlrev_b32 v30, 16, v75
    v_and_b32 v31, 0xffff0000, v75
    v_pk_add_f32 v[32:33], v[32:33], v[24:25]
    v_pk_fma_f32 v[40:41], v[24:25], v[24:25], v[40:41]
    v_pk_add_f32 v[34:35], v[34:35], v[26:27]
    v_pk_fma_f32 v[42:43], v[26:27], v[26:27], v[42:43]
    v_pk_add_f32 v[36:37], v[36:37], v[28:29]
    v_pk_fma_f32 v[44:45], v[28:29], v[28:29], v[44:45]
    v_pk_add_f32 v[38:39], v[38:39], v[30:31]
    v_pk_fma_f32 v[46:47], v[30:31], v[30:31], v[46:47]
    v_lshlrev_b32 v24, 16, v76
    v_and_b32 v25, 0xffff0000, v76
    v_lshlrev_b32 v26, 16, v77
    v_and_b32 v27, 0xffff0000, v77
    v_lshlrev_b32 v28, 16, v78
    v_and_b32 v29, 0xffff0000, v78
    v_lshlrev_b32 v30, 16, v79
    v_and_b32 v31, 0xffff0000, v79
    v_pk_add_f32 v[32:33], v[32:33], v[24:25]
    v_pk_fma_f32 v[40:41], v[24:25], v[24:25], v[40:41]
    v_pk_add_f32 v[34:35], v[34:35], v[26:27]
    v_pk_fma_f32 v[42:43], v[26:27], v[26:27], v[42:43]
    v_pk_add_f32 v[36:37], v[36:37], v[28:29]
    v_pk_fma_f32 v[44:45], v[28:29], v[28:29], v[44:45]
    v_pk_add_f32 v[38:39], v[38:39], v[30:31]
    v_pk_fma_f32 v[46:47], v[30:31], v[30:31], v[46:47]
    ds_write_b32 v9, v32 offset:0
    ds_write_b32 v9, v40 offset:16384
    ds_write_b32 v9, v33 offset:256
    ds_write_b32 v9, v41 offset:16640
    ds_write_b32 v9, v34 offset:512
    ds_write_b32 v9, v42 offset:16896
    ds_write_b32 v9, v35 offset:768
    ds_write_b32 v9, v43 offset:17152
    ds_write_b32 v9, v36 offset:1024
    ds_write_b32 v9, v44 offset:17408
    ds_write_b32 v9, v37 offset:1280
    ds_write_b32 v9, v45 offset:17664
    ds_write_b32 v9, v38 offset:1536
    ds_write_b32 v9, v46 offset:17920
    ds_write_b32 v9, v39 offset:1792
    ds_write_b32 v9, v47 offset:18176
    s_waitcnt lgkmcnt(0)
    s_barrier
    s_add_u32 s83, s2, s5
    s_cmp_lg_u32 s83, 0
    s_cbranch_scc1 K3_NOEP
    v_mov_b32 v82, s100
    v_mov_b32 v83, s101
    s_mov_b32 s83, 0x540000
    s_mov_b64 exec, 1
    buffer_store_dwordx2 v[82:83], off, s[12:15], s83
    s_mov_b64 exec, -1
K3_NOEP:
    ds_read_b128 v[48:51], v10 offset:0
    ds_read_b128 v[52:55], v10 offset:16
    ds_read_b128 v[56:59], v10 offset:32
    ds_read_b128 v[60:63], v10 offset:48
    v_lshrrev_b32 v11, 2, v0
    v_lshlrev_b32 v11, 2, v11
    s_waitcnt lgkmcnt(0)
    v_add_f32 v48, v48, v56
    v_add_f32 v49, v49, v57
    v_add_f32 v50, v50, v58
    v_add_f32 v51, v51, v59
    v_add_f32 v52, v52, v60
    v_add_f32 v53, v53, v61
    v_add_f32 v54, v54, v62
    v_add_f32 v55, v55, v63
    v_add_f32 v48, v48, v52
    v_add_f32 v49, v49, v53
    v_add_f32 v50, v50, v54
    v_add_f32 v51, v51, v55
    v_add_f32 v48, v48, v50
    v_add_f32 v49, v49, v51
    v_add_f32 v48, v48, v49
    s_nop 1
    v_add_f32_dpp v48, v48, v48 quad_perm:[1,0,3,2] row_mask:0xf bank_mask:0xf
    s_nop 1
    v_add_f32_dpp v48, v48, v48 quad_perm:[2,3,0,1] row_mask:0xf bank_mask:0xf
    ds_write_b32 v11, v48 offset:32768
    s_waitcnt lgkmcnt(0)
    s_barrier
    v_lshlrev_b32 v11, 2, v1
    ds_read_b32 v32, v11 offset:32768
    ds_read_b32 v33, v11 offset:33024
    s_waitcnt lgkmcnt(0)
    s_barrier
    s_sub_u32 s5, s5, 4
    s_cbranch_scc0 K4_LV0
    s_add_u32 s5, s5, 4
    s_mov_b32 s43, 0
    s_cmp_lg_u32 s5, 0
    s_cbranch_scc1 K4_COMPUTE
    v_mul_f32 v32, 0x3b000000, v32
    v_mul_f32 v32, v32, v32
    v_mov_b32 v34, 0x3b000000
    v_fma_f32 v33, v33, v34, -v32
    v_max_f32 v33, 0, v33
    v_cvt_pk_bf16_f32 v33, v33, v33
    v_lshlrev_b32 v33, 16, v33
    v_add_f32 v33, 0x3727c5ac, v33
    v_cvt_pk_bf16_f32 v33, v33, v33
    v_lshlrev_b32 v33, 16, v33
    v_sqrt_f32 v33, v33
    s_nop 0
    v_cvt_pk_bf16_f32 v33, v33, v33
    v_lshlrev_b32 v33, 16, v33
    v_rcp_f32 v33, v33
    s_nop 0
    buffer_store_dword v33, v11, s[12:15], s44 offen sc1
    s_lshl_b32 s43, s3, 1
    s_add_u32 s43, s43, s4
    s_lshl_b32 s43, s43, 12
    s_add_u32 s43, s43, 0x560e00
    s_branch K4_COMPUTE
K3_COMPUTE:
    s_and_b32 s82, s5, 3
    s_lshl_b32 s82, s82, 11
    s_add_u32 s82, s82, 0x5a0000
    v_lshlrev_b32 v248, 5, v1
    buffer_load_dwordx2 v[250:251], v248, s[12:15], s82 offen sc1
    s_setprio 3
    s_and_b32 s60, s5, 1
    s_lshr_b32 s61, s5, 1
    v_lshrrev_b32 v3, 5, v1
    v_bfe_u32 v4, v1, 2, 2
    v_lshl_add_u32 v5, v3, 2, v4
    v_lshlrev_b32 v5, 8, v5
    v_bfe_u32 v6, v1, 4, 1
    v_lshl_add_u32 v5, v6, 5, v5
    v_and_b32 v6, 3, v1
    v_lshl_add_u32 v5, v6, 3, v5
    s_lshl_b32 s46, s60, 1
    v_xor_b32 v6, s46, v4
    v_lshl_add_u32 v12, v6, 6, v5
    v_add_u32 v12, 81920, v12
    v_xor_b32 v13, 64, v12
    v_add_u32 v14, 65536, v12
    v_add_u32 v15, 65536, v13
    s_and_b32 s3, s2, 7
    s_lshr_b32 s6, s2, 3
    s_lshl_b32 s3, s3, 1
    s_sub_u32 s6, s6, 4
    s_sub_u32 s4, s6, 14
    s_cmp_lt_u32 s6, 14
    s_cselect_b32 s4, s6, s4
    s_subb_u32 s3, s3, -1
    s_lshl_b32 s46, s61, 1
    s_add_u32 s46, s46, s60
    v_xor_b32 v6, s46, v4
    v_lshl_add_u32 v8, v6, 6, v5
    v_xor_b32 v9, 64, v8
    v_add_u32 v10, 65536, v8
    v_add_u32 v11, 65536, v9
    v_and_b32 v7, 31, v1
    v_mul_u32_u24 v2, 7168, v3
    v_lshl_add_u32 v2, v7, 2, v2
    v_mov_b32 v18, 0
    v_mov_b32 v19, 0
    v_mov_b32 v22, 0
    v_mov_b32 v23, 0
    v_mov_b32 v26, 0
    v_mov_b32 v27, 0
    v_mov_b32 v30, 0
    v_mov_b32 v31, 0
    v_mov_b32 v40, 0
    v_mov_b32 v41, 0
    v_mov_b32 v42, 0
    v_mov_b32 v43, 0
    s_lshl_b32 s46, s5, 8
    s_add_u32 s46, s46, 65536
    v_lshl_add_u32 v7, v1, 2, s46
    v_xor_b32 v37, 256, v7
    v_and_b32 v6, 1, v1
    v_cmp_eq_u32 vcc, 0, v6
    v_mov_b32 v6, 0x3f803f80
    v_cndmask_b32 v32, 0, v6, vcc
    v_cndmask_b32 v33, 0, v6, vcc
    v_sub_u32 v34, v6, v32
    v_sub_u32 v35, v6, v32
    v_bfe_u32 v6, v1, 1, 1
    v_mul_u32_u24 v6, 0xaaaa, v6
    v_or_b32 v36, 0x4444, v6
    v_and_b32 v6, 16, v1
    v_cmp_eq_u32 s[62:63], 0, v6
    v_lshlrev_b32 v6, 4, v1
    s_lshl_b32 s45, s4, 9
    s_lshl_b32 s46, s60, 8
    s_add_u32 s45, s45, s46
    s_add_u32 s45, s45, 0x550000
    s_lshl_b32 s43, s3, 1
    s_add_u32 s43, s43, s61
    s_lshl_b32 s43, s43, 5
    s_lshl_b32 s46, s4, 1
    s_add_u32 s43, s43, s46
    s_add_u32 s43, s43, s60
    s_lshl_b32 s43, s43, 7
    s_add_u32 s43, s43, 0x560000
    s_mov_b32 s44, 0
    s_lshl_b32 s56, s3, 2
    s_lshl_b32 s57, s61, 1
    s_add_u32 s56, s56, s57
    s_add_u32 s56, s56, s60
    s_lshl_b32 s57, s4, 3
    s_lshl_b32 s58, s60, 2
    s_add_u32 s57, s57, s58
    s_mul_i32 s58, s56, 114688
    s_lshl_b32 s59, s57, 10
    s_add_u32 s58, s58, s59
    s_add_u32 s58, s58, 0x600000
    s_lshr_b32 s59, s4, 1
    s_lshl2_add_u32 s56, s56, s59
    s_mul_i32 s56, s56, 16512
    s_and_b32 s59, s57, 15
    s_lshl_b32 s59, s59, 10
    s_add_u32 s56, s56, s59
    s_add_u32 s56, s56, 0x1000000
    s_movk_i32 s59, 1024
    s_mov_b32 s57, 114688
    s_cmp_lt_u32 s4, 4
    s_cselect_b32 s48, s56, s58
    s_cselect_b32 s57, 66048, s57
    s_sub_u32 s58, 0, s57
    s_cmp_eq_u32 s60, 0
    s_cselect_b32 s57, s57, s58
    s_add_u32 s49, s48, s59
    s_add_u32 s50, s49, s59
    s_add_u32 s51, s50, s59
    s_add_u32 s52, s48, s57
    s_add_u32 s53, s49, s57
    s_add_u32 s54, s50, s57
    s_add_u32 s55, s51, s57
    s_waitcnt vmcnt(0)
    s_mov_b32 s83, 0
FD_CC:
    v_cmp_ne_u64 vcc, s[100:101], v[250:251]
    s_add_u32 s83, s83, 1
    s_cbranch_vccz FD_DC
    s_cmp_gt_u32 s83, 131072
    s_cbranch_scc1 FD_DC
    buffer_load_dwordx2 v[250:251], v248, s[12:15], s82 offen sc1
    s_waitcnt vmcnt(0)
    s_branch FD_CC
FD_DC:
    s_barrier
    buffer_load_dword v44, v2, s[12:15], s45 offen offset:0 sc1
    buffer_load_dword v48, v2, s[12:15], s45 offen offset:128 sc1
    s_add_u32 s46, s45, 14336
    buffer_load_dword v45, v2, s[12:15], s46 offen offset:0 sc1
    buffer_load_dword v49, v2, s[12:15], s46 offen offset:128 sc1
    s_add_u32 s46, s45, 28672
    buffer_load_dword v46, v2, s[12:15], s46 offen offset:0 sc1
    buffer_load_dword v50, v2, s[12:15], s46 offen offset:128 sc1
    s_add_u32 s46, s45, 43008
    buffer_load_dword v47, v2, s[12:15], s46 offen offset:0 sc1
    buffer_load_dword v51, v2, s[12:15], s46 offen offset:128 sc1
    ds_read_b64_tr_b16 v[152:153], v12 offset:32768
    ds_read_b64_tr_b16 v[154:155], v12 offset:34816
    ds_read_b64_tr_b16 v[156:157], v13 offset:32768
    ds_read_b64_tr_b16 v[158:159], v13 offset:34816
    ds_read_b64_tr_b16 v[160:161], v12 offset:36864
    ds_read_b64_tr_b16 v[162:163], v12 offset:38912
    ds_read_b64_tr_b16 v[164:165], v13 offset:36864
    ds_read_b64_tr_b16 v[166:167], v13 offset:38912
    ds_read_b64_tr_b16 v[168:169], v12 offset:40960
    ds_read_b64_tr_b16 v[170:171], v12 offset:43008
    ds_read_b64_tr_b16 v[172:173], v13 offset:40960
    ds_read_b64_tr_b16 v[174:175], v13 offset:43008
    ds_read_b64_tr_b16 v[176:177], v12 offset:45056
    ds_read_b64_tr_b16 v[178:179], v12 offset:47104
    ds_read_b64_tr_b16 v[180:181], v13 offset:45056
    ds_read_b64_tr_b16 v[182:183], v13 offset:47104
    ds_read_b64_tr_b16 v[184:185], v12 offset:49152
    ds_read_b64_tr_b16 v[186:187], v12 offset:51200
    ds_read_b64_tr_b16 v[188:189], v13 offset:49152
    ds_read_b64_tr_b16 v[190:191], v13 offset:51200
    ds_read_b64_tr_b16 v[192:193], v12 offset:53248
    ds_read_b64_tr_b16 v[194:195], v12 offset:55296
    ds_read_b64_tr_b16 v[196:197], v12 offset:57344
    ds_read_b64_tr_b16 v[198:199], v12 offset:59392
    ds_read_b64_tr_b16 v[200:201], v13 offset:53248
    ds_read_b64_tr_b16 v[202:203], v13 offset:55296
    ds_read_b64_tr_b16 v[204:205], v12 offset:61440
    ds_read_b64_tr_b16 v[206:207], v12 offset:63488
    ds_read_b64_tr_b16 v[208:209], v13 offset:57344
    ds_read_b64_tr_b16 v[210:211], v13 offset:59392
    ds_read_b64_tr_b16 v[212:213], v14 offset:0
    ds_read_b64_tr_b16 v[214:215], v14 offset:2048
    ds_read_b64_tr_b16 v[216:217], v13 offset:61440
    ds_read_b64_tr_b16 v[218:219], v13 offset:63488
    ds_read_b64_tr_b16 v[220:221], v14 offset:4096
    ds_read_b64_tr_b16 v[222:223], v14 offset:6144
    ds_read_b64_tr_b16 v[224:225], v15 offset:0
    ds_read_b64_tr_b16 v[226:227], v15 offset:2048
    ds_read_b64_tr_b16 v[228:229], v14 offset:8192
    ds_read_b64_tr_b16 v[230:231], v14 offset:10240
    ds_read_b64_tr_b16 v[232:233], v15 offset:4096
    ds_read_b64_tr_b16 v[234:235], v15 offset:6144
    ds_read_b64_tr_b16 v[236:237], v14 offset:12288
    ds_read_b64_tr_b16 v[238:239], v14 offset:14336
    ds_read_b64_tr_b16 v[240:241], v15 offset:8192
    ds_read_b64_tr_b16 v[242:243], v15 offset:10240
    ds_read_b64_tr_b16 v[244:245], v15 offset:12288
    ds_read_b64_tr_b16 v[246:247], v15 offset:14336
    s_waitcnt lgkmcnt(0)
    s_barrier
    s_waitcnt vmcnt(0)
K3_CC:
    v_max3_u32 v24, v44, v45, v46
    v_max3_u32 v24, v24, v47, v48
    v_max3_u32 v24, v24, v49, v50
    v_max_u32 v24, v24, v51
    s_add_u32 s44, s44, 1
    v_cmp_eq_u32 vcc, -1, v24
    s_cmp_gt_u32 s44, 131072
    s_cbranch_scc1 K3_CD
    s_cbranch_vccz K3_CD
    buffer_load_dword v44, v2, s[12:15], s45 offen offset:0 sc1
    buffer_load_dword v48, v2, s[12:15], s45 offen offset:128 sc1
    s_add_u32 s46, s45, 14336
    buffer_load_dword v45, v2, s[12:15], s46 offen offset:0 sc1
    buffer_load_dword v49, v2, s[12:15], s46 offen offset:128 sc1
    s_add_u32 s46, s45, 28672
    buffer_load_dword v46, v2, s[12:15], s46 offen offset:0 sc1
    buffer_load_dword v50, v2, s[12:15], s46 offen offset:128 sc1
    s_add_u32 s46, s45, 43008
    buffer_load_dword v47, v2, s[12:15], s46 offen offset:0 sc1
    buffer_load_dword v51, v2, s[12:15], s46 offen offset:128 sc1
    s_waitcnt vmcnt(0)
    s_branch K3_CC
K3_CD:
    v_add_f32 v44, v44, v46
    v_add_f32 v45, v45, v47
    v_add_f32 v44, v44, v45
    v_mov_b32 v45, 0
    s_nop 1
    v_permlane32_swap_b32 v44, v45
    s_nop 0
    v_add_f32 v16, v44, v45
    v_cvt_pk_bf16_f32 v24, v16, v16
    v_lshlrev_b32 v25, 16, v24
    v_sub_f32 v16, v16, v25
    v_cvt_pk_bf16_f32 v28, v16, v16
    v_lshlrev_b32 v25, 16, v28
    v_sub_f32 v17, v16, v25
    v_alignbit_b32 v16, v28, v24, 16
    v_cvt_pk_bf16_f32 v17, v17, 0
    v_add_f32 v48, v48, v50
    v_add_f32 v49, v49, v51
    v_add_f32 v48, v48, v49
    v_mov_b32 v49, 0
    s_nop 1
    v_permlane32_swap_b32 v48, v49
    s_nop 0
    v_add_f32 v20, v48, v49
    v_cvt_pk_bf16_f32 v24, v20, v20
    v_lshlrev_b32 v25, 16, v24
    v_sub_f32 v20, v20, v25
    v_cvt_pk_bf16_f32 v28, v20, v20
    v_lshlrev_b32 v25, 16, v28
    v_sub_f32 v21, v20, v25
    v_alignbit_b32 v20, v28, v24, 16
    v_cvt_pk_bf16_f32 v21, v21, 0
    s_barrier
    ds_read_b64_tr_b16 v[108:109], v8 offset:0
    ds_read_b64_tr_b16 v[110:111], v8 offset:2048
    s_waitcnt lgkmcnt(0)
    v_mfma_f32_32x32x16_bf16 v[44:59], v[152:155], v[108:111], 0
    ds_read_b64_tr_b16 v[132:133], v9 offset:0
    ds_read_b64_tr_b16 v[134:135], v9 offset:2048
    ds_read_b64_tr_b16 v[112:113], v8 offset:4096
    v_mfma_f32_32x32x16_bf16 v[60:75], v[156:159], v[108:111], 0
    ds_read_b64_tr_b16 v[114:115], v8 offset:6144
    ds_read_b64_tr_b16 v[136:137], v9 offset:4096
    s_waitcnt lgkmcnt(3)
    v_mfma_f32_32x32x16_bf16 v[92:107], v[156:159], v[132:135], 0
    ds_read_b64_tr_b16 v[138:139], v9 offset:6144
    ds_read_b64_tr_b16 v[116:117], v8 offset:8192
    v_mfma_f32_32x32x16_bf16 v[76:91], v[152:155], v[132:135], 0
    ds_read_b64_tr_b16 v[118:119], v8 offset:10240
    ds_read_b64_tr_b16 v[120:121], v8 offset:12288
    s_waitcnt lgkmcnt(5)
    v_mfma_f32_32x32x16_bf16 v[44:59], v[160:163], v[112:115], v[44:59]
    ds_read_b64_tr_b16 v[122:123], v8 offset:14336
    v_mfma_f32_32x32x16_bf16 v[60:75], v[164:167], v[112:115], v[60:75]
    v_smfmac_f32_16x16x64_bf16 v[40:43], v[32:35], v[108:115], v36
    ds_read_b64_tr_b16 v[140:141], v9 offset:8192
    ds_read_b64_tr_b16 v[142:143], v9 offset:10240
    s_waitcnt lgkmcnt(2)
    v_mfma_f32_32x32x16_bf16 v[92:107], v[164:167], v[136:139], v[92:107]
    v_mfma_f32_32x32x16_bf16 v[44:59], v[168:171], v[116:119], v[44:59]
    s_barrier
    ds_read_b64_tr_b16 v[124:125], v8 offset:16384
    ds_read_b64_tr_b16 v[126:127], v8 offset:18432
    v_mfma_f32_32x32x16_bf16 v[60:75], v[172:175], v[116:119], v[60:75]
    v_mfma_f32_32x32x16_bf16 v[44:59], v[176:179], v[120:123], v[44:59]
    ds_read_b64_tr_b16 v[128:129], v8 offset:20480
    ds_read_b64_tr_b16 v[130:131], v8 offset:22528
    v_mfma_f32_32x32x16_bf16 v[60:75], v[180:183], v[120:123], v[60:75]
    ds_read_b64_tr_b16 v[144:145], v9 offset:12288
    ds_read_b64_tr_b16 v[146:147], v9 offset:14336
    v_smfmac_f32_16x16x64_bf16 v[40:43], v[32:35], v[116:123], v36
    s_waitcnt lgkmcnt(4)
    v_mfma_f32_32x32x16_bf16 v[92:107], v[172:175], v[140:143], v[92:107]
    ds_read_b64_tr_b16 v[108:109], v8 offset:24576
    ds_read_b64_tr_b16 v[110:111], v8 offset:26624
    v_mfma_f32_32x32x16_bf16 v[76:91], v[160:163], v[136:139], v[76:91]
    v_mfma_f32_32x32x16_bf16 v[44:59], v[184:187], v[124:127], v[44:59]
    ds_read_b64_tr_b16 v[148:149], v9 offset:16384
    ds_read_b64_tr_b16 v[150:151], v9 offset:18432
    v_mfma_f32_32x32x16_bf16 v[60:75], v[188:191], v[124:127], v[60:75]
    s_waitcnt lgkmcnt(2)
    v_mfma_f32_32x32x16_bf16 v[44:59], v[192:195], v[128:131], v[44:59]
    ds_read_b64_tr_b16 v[112:113], v8 offset:28672
    ds_read_b64_tr_b16 v[114:115], v8 offset:30720
    v_mfma_f32_32x32x16_bf16 v[92:107], v[180:183], v[144:147], v[92:107]
    v_smfmac_f32_16x16x64_bf16 v[40:43], v[32:35], v[124:131], v36
    v_mfma_f32_32x32x16_bf16 v[44:59], v[196:199], v[108:111], v[44:59]
    s_barrier
    ds_read_b64_tr_b16 v[116:117], v8 offset:32768
    ds_read_b64_tr_b16 v[118:119], v8 offset:34816
    v_mfma_f32_32x32x16_bf16 v[60:75], v[200:203], v[128:131], v[60:75]
    s_waitcnt lgkmcnt(2)
    v_mfma_f32_32x32x16_bf16 v[92:107], v[188:191], v[148:151], v[92:107]
    ds_read_b64_tr_b16 v[156:157], v9 offset:20480
    ds_read_b64_tr_b16 v[158:159], v9 offset:22528
    v_mfma_f32_32x32x16_bf16 v[76:91], v[168:171], v[140:143], v[76:91]
    ds_read_b64_tr_b16 v[120:121], v8 offset:36864
    ds_read_b64_tr_b16 v[122:123], v8 offset:38912
    v_mfma_f32_32x32x16_bf16 v[44:59], v[204:207], v[112:115], v[44:59]
    v_mfma_f32_32x32x16_bf16 v[60:75], v[208:211], v[108:111], v[60:75]
    v_smfmac_f32_16x16x64_bf16 v[40:43], v[32:35], v[108:115], v36
    ds_read_b64_tr_b16 v[132:133], v9 offset:24576
    ds_read_b64_tr_b16 v[134:135], v9 offset:26624
    s_waitcnt lgkmcnt(2)
    v_mfma_f32_32x32x16_bf16 v[44:59], v[212:215], v[116:119], v[44:59]
    ds_read_b64_tr_b16 v[124:125], v8 offset:40960
    ds_read_b64_tr_b16 v[126:127], v8 offset:43008
    v_mfma_f32_32x32x16_bf16 v[60:75], v[216:219], v[112:115], v[60:75]
    v_mfma_f32_32x32x16_bf16 v[92:107], v[200:203], v[156:159], v[92:107]
    ds_read_b64_tr_b16 v[128:129], v8 offset:45056
    ds_read_b64_tr_b16 v[130:131], v8 offset:47104
    v_mfma_f32_32x32x16_bf16 v[44:59], v[220:223], v[120:123], v[44:59]
    v_mfma_f32_32x32x16_bf16 v[60:75], v[224:227], v[116:119], v[60:75]
    v_smfmac_f32_16x16x64_bf16 v[40:43], v[32:35], v[116:123], v36
    ds_read_b64_tr_b16 v[152:153], v9 offset:28672
    ds_read_b64_tr_b16 v[154:155], v9 offset:30720
    s_waitcnt lgkmcnt(2)
    v_mfma_f32_32x32x16_bf16 v[92:107], v[208:211], v[132:135], v[92:107]
    v_mfma_f32_32x32x16_bf16 v[44:59], v[228:231], v[124:127], v[44:59]
    s_barrier
    ds_read_b64_tr_b16 v[164:165], v12 offset:0
    ds_read_b64_tr_b16 v[166:167], v12 offset:2048
    v_mfma_f32_32x32x16_bf16 v[60:75], v[232:235], v[120:123], v[60:75]
    ds_read_b64_tr_b16 v[108:109], v8 offset:49152
    ds_read_b64_tr_b16 v[110:111], v8 offset:51200
    v_mfma_f32_32x32x16_bf16 v[44:59], v[236:239], v[128:131], v[44:59]
    ds_read_b64_tr_b16 v[172:173], v9 offset:32768
    ds_read_b64_tr_b16 v[174:175], v9 offset:34816
    v_mfma_f32_32x32x16_bf16 v[60:75], v[240:243], v[124:127], v[60:75]
    ds_read_b64_tr_b16 v[136:137], v12 offset:4096
    ds_read_b64_tr_b16 v[138:139], v12 offset:6144
    v_smfmac_f32_16x16x64_bf16 v[40:43], v[32:35], v[124:131], v36
    ds_read_b64_tr_b16 v[112:113], v8 offset:53248
    ds_read_b64_tr_b16 v[114:115], v8 offset:55296
    s_waitcnt lgkmcnt(4)
    v_mfma_f32_32x32x16_bf16 v[92:107], v[216:219], v[152:155], v[92:107]
    ds_read_b64_tr_b16 v[160:161], v12 offset:8192
    ds_read_b64_tr_b16 v[162:163], v12 offset:10240
    v_mfma_f32_32x32x16_bf16 v[76:91], v[176:179], v[144:147], v[76:91]
    ds_read_b64_tr_b16 v[116:117], v8 offset:57344
    ds_read_b64_tr_b16 v[118:119], v8 offset:59392
    v_mfma_f32_32x32x16_bf16 v[44:59], v[164:167], v[108:111], v[44:59]
    ds_read_b64_tr_b16 v[180:181], v13 offset:0
    ds_read_b64_tr_b16 v[182:183], v13 offset:2048
    v_mfma_f32_32x32x16_bf16 v[92:107], v[224:227], v[172:175], v[92:107]
    ds_read_b64_tr_b16 v[188:189], v9 offset:36864
    ds_read_b64_tr_b16 v[190:191], v9 offset:38912
    s_waitcnt lgkmcnt(4)
    v_mfma_f32_32x32x16_bf16 v[44:59], v[136:139], v[112:115], v[44:59]
    ds_read_b64_tr_b16 v[140:141], v12 offset:12288
    ds_read_b64_tr_b16 v[142:143], v12 offset:14336
    v_mfma_f32_32x32x16_bf16 v[60:75], v[244:247], v[128:131], v[60:75]
    ds_read_b64_tr_b16 v[120:121], v8 offset:61440
    ds_read_b64_tr_b16 v[122:123], v8 offset:63488
    v_smfmac_f32_16x16x64_bf16 v[40:43], v[32:35], v[108:115], v36
    ds_read_b64_tr_b16 v[168:169], v13 offset:4096
    ds_read_b64_tr_b16 v[170:171], v13 offset:6144
    v_mfma_f32_32x32x16_bf16 v[44:59], v[160:163], v[116:119], v[44:59]
    s_barrier
    ds_read_b64_tr_b16 v[200:201], v12 offset:16384
    ds_read_b64_tr_b16 v[202:203], v12 offset:18432
    s_waitcnt lgkmcnt(4)
    v_mfma_f32_32x32x16_bf16 v[60:75], v[180:183], v[108:111], v[60:75]
    ds_read_b64_tr_b16 v[124:125], v10 offset:0
    ds_read_b64_tr_b16 v[126:127], v10 offset:2048
    v_mfma_f32_32x32x16_bf16 v[92:107], v[232:235], v[188:191], v[92:107]
    ds_read_b64_tr_b16 v[208:209], v13 offset:8192
    ds_read_b64_tr_b16 v[210:211], v13 offset:10240
    v_mfma_f32_32x32x16_bf16 v[76:91], v[184:187], v[148:151], v[76:91]
    ds_read_b64_tr_b16 v[216:217], v9 offset:40960
    ds_read_b64_tr_b16 v[218:219], v9 offset:43008
    v_mfma_f32_32x32x16_bf16 v[44:59], v[140:143], v[120:123], v[44:59]
    ds_read_b64_tr_b16 v[144:145], v12 offset:20480
    ds_read_b64_tr_b16 v[146:147], v12 offset:22528
    s_waitcnt lgkmcnt(4)
    v_mfma_f32_32x32x16_bf16 v[60:75], v[168:171], v[112:115], v[60:75]
    ds_read_b64_tr_b16 v[128:129], v10 offset:4096
    ds_read_b64_tr_b16 v[130:131], v10 offset:6144
    v_smfmac_f32_16x16x64_bf16 v[40:43], v[32:35], v[116:123], v36
    ds_read_b64_tr_b16 v[176:177], v13 offset:12288
    ds_read_b64_tr_b16 v[178:179], v13 offset:14336
    v_mfma_f32_32x32x16_bf16 v[44:59], v[200:203], v[124:127], v[44:59]
    ds_read_b64_tr_b16 v[224:225], v9 offset:45056
    ds_read_b64_tr_b16 v[226:227], v9 offset:47104
    v_mfma_f32_32x32x16_bf16 v[60:75], v[208:211], v[116:119], v[60:75]
    ds_read_b64_tr_b16 v[232:233], v12 offset:24576
    ds_read_b64_tr_b16 v[234:235], v12 offset:26624
    s_waitcnt lgkmcnt(4)
    v_mfma_f32_32x32x16_bf16 v[92:107], v[240:243], v[216:219], v[92:107]
    ds_read_b64_tr_b16 v[108:109], v10 offset:8192
    ds_read_b64_tr_b16 v[110:111], v10 offset:10240
    v_mfma_f32_32x32x16_bf16 v[44:59], v[144:147], v[128:131], v[44:59]
    ds_read_b64_tr_b16 v[148:149], v13 offset:16384
    ds_read_b64_tr_b16 v[150:151], v13 offset:18432
    v_mfma_f32_32x32x16_bf16 v[60:75], v[176:179], v[120:123], v[60:75]
    ds_read_b64_tr_b16 v[184:185], v9 offset:49152
    ds_read_b64_tr_b16 v[186:187], v9 offset:51200
    v_smfmac_f32_16x16x64_bf16 v[40:43], v[32:35], v[124:131], v36
    ds_read_b64_tr_b16 v[240:241], v12 offset:28672
    ds_read_b64_tr_b16 v[242:243], v12 offset:30720
    s_waitcnt lgkmcnt(4)
    v_mfma_f32_32x32x16_bf16 v[92:107], v[244:247], v[224:227], v[92:107]
    ds_read_b64_tr_b16 v[112:113], v10 offset:12288
    ds_read_b64_tr_b16 v[114:115], v10 offset:14336
    v_mfma_f32_32x32x16_bf16 v[76:91], v[192:195], v[156:159], v[76:91]
    ds_read_b64_tr_b16 v[244:245], v13 offset:20480
    ds_read_b64_tr_b16 v[246:247], v13 offset:22528
    v_mfma_f32_32x32x16_bf16 v[44:59], v[232:235], v[108:111], v[44:59]
    ds_read_b64_tr_b16 v[156:157], v9 offset:53248
    ds_read_b64_tr_b16 v[158:159], v9 offset:55296
    v_mfma_f32_32x32x16_bf16 v[60:75], v[148:151], v[124:127], v[60:75]
    s_waitcnt lgkmcnt(2)
    v_mfma_f32_32x32x16_bf16 v[92:107], v[180:183], v[184:187], v[92:107]
    s_barrier
    ds_read_b64_tr_b16 v[192:193], v12 offset:32768
    ds_read_b64_tr_b16 v[194:195], v12 offset:34816
    v_mfma_f32_32x32x16_bf16 v[76:91], v[196:199], v[132:135], v[76:91]
    ds_read_b64_tr_b16 v[116:117], v8 offset:0
    ds_read_b64_tr_b16 v[118:119], v8 offset:2048
    v_mfma_f32_32x32x16_bf16 v[44:59], v[240:243], v[112:115], v[44:59]
    ds_read_b64_tr_b16 v[180:181], v13 offset:24576
    ds_read_b64_tr_b16 v[182:183], v13 offset:26624
    v_mfma_f32_32x32x16_bf16 v[60:75], v[244:247], v[128:131], v[60:75]
    ds_read_b64_tr_b16 v[132:133], v9 offset:57344
    ds_read_b64_tr_b16 v[134:135], v9 offset:59392
    v_smfmac_f32_16x16x64_bf16 v[40:43], v[32:35], v[108:115], v36
    ds_read_b64_tr_b16 v[196:197], v12 offset:36864
    ds_read_b64_tr_b16 v[198:199], v12 offset:38912
    s_waitcnt lgkmcnt(4)
    v_mfma_f32_32x32x16_bf16 v[92:107], v[168:171], v[156:159], v[92:107]
    ds_read_b64_tr_b16 v[120:121], v8 offset:4096
    ds_read_b64_tr_b16 v[122:123], v8 offset:6144
    v_mfma_f32_32x32x16_bf16 v[76:91], v[204:207], v[152:155], v[76:91]
    ds_read_b64_tr_b16 v[168:169], v13 offset:28672
    ds_read_b64_tr_b16 v[170:171], v13 offset:30720
    v_mfma_f32_32x32x16_bf16 v[44:59], v[192:195], v[116:119], v[44:59]
    ds_read_b64_tr_b16 v[152:153], v9 offset:61440
    ds_read_b64_tr_b16 v[154:155], v9 offset:63488
    v_mfma_f32_32x32x16_bf16 v[60:75], v[180:183], v[108:111], v[60:75]
    s_waitcnt lgkmcnt(2)
    v_mfma_f32_32x32x16_bf16 v[92:107], v[208:211], v[132:135], v[92:107]
    ds_read_b64_tr_b16 v[204:205], v12 offset:40960
    ds_read_b64_tr_b16 v[206:207], v12 offset:43008
    v_mfma_f32_32x32x16_bf16 v[76:91], v[212:215], v[172:175], v[76:91]
    ds_read_b64_tr_b16 v[124:125], v8 offset:8192
    ds_read_b64_tr_b16 v[126:127], v8 offset:10240
    v_mfma_f32_32x32x16_bf16 v[44:59], v[196:199], v[120:123], v[44:59]
    ds_read_b64_tr_b16 v[208:209], v13 offset:32768
    ds_read_b64_tr_b16 v[210:211], v13 offset:34816
    v_mfma_f32_32x32x16_bf16 v[60:75], v[168:171], v[112:115], v[60:75]
    ds_read_b64_tr_b16 v[172:173], v11 offset:0
    ds_read_b64_tr_b16 v[174:175], v11 offset:2048
    v_smfmac_f32_16x16x64_bf16 v[40:43], v[32:35], v[116:123], v36
    ds_read_b64_tr_b16 v[212:213], v12 offset:45056
    ds_read_b64_tr_b16 v[214:215], v12 offset:47104
    s_waitcnt lgkmcnt(4)
    v_mfma_f32_32x32x16_bf16 v[92:107], v[176:179], v[152:155], v[92:107]
    ds_read_b64_tr_b16 v[128:129], v8 offset:12288
    ds_read_b64_tr_b16 v[130:131], v8 offset:14336
    v_mfma_f32_32x32x16_bf16 v[76:91], v[220:223], v[188:191], v[76:91]
    ds_read_b64_tr_b16 v[176:177], v13 offset:36864
    ds_read_b64_tr_b16 v[178:179], v13 offset:38912
    v_mfma_f32_32x32x16_bf16 v[44:59], v[204:207], v[124:127], v[44:59]
    ds_read_b64_tr_b16 v[188:189], v11 offset:4096
    ds_read_b64_tr_b16 v[190:191], v11 offset:6144
    v_mfma_f32_32x32x16_bf16 v[60:75], v[208:211], v[116:119], v[60:75]
    s_waitcnt lgkmcnt(2)
    v_mfma_f32_32x32x16_bf16 v[92:107], v[148:151], v[172:175], v[92:107]
    s_barrier
    ds_read_b64_tr_b16 v[220:221], v12 offset:49152
    ds_read_b64_tr_b16 v[222:223], v12 offset:51200
    v_mfma_f32_32x32x16_bf16 v[76:91], v[228:231], v[216:219], v[76:91]
    ds_read_b64_tr_b16 v[108:109], v8 offset:16384
    ds_read_b64_tr_b16 v[110:111], v8 offset:18432
    v_mfma_f32_32x32x16_bf16 v[44:59], v[212:215], v[128:131], v[44:59]
    ds_read_b64_tr_b16 v[148:149], v13 offset:40960
    ds_read_b64_tr_b16 v[150:151], v13 offset:43008
    v_mfma_f32_32x32x16_bf16 v[60:75], v[176:179], v[120:123], v[60:75]
    ds_read_b64_tr_b16 v[216:217], v11 offset:8192
    ds_read_b64_tr_b16 v[218:219], v11 offset:10240
    v_smfmac_f32_16x16x64_bf16 v[40:43], v[32:35], v[124:131], v36
    ds_read_b64_tr_b16 v[228:229], v12 offset:53248
    ds_read_b64_tr_b16 v[230:231], v12 offset:55296
    s_waitcnt lgkmcnt(4)
    v_mfma_f32_32x32x16_bf16 v[92:107], v[244:247], v[188:191], v[92:107]
    ds_read_b64_tr_b16 v[112:113], v8 offset:20480
    ds_read_b64_tr_b16 v[114:115], v8 offset:22528
    v_mfma_f32_32x32x16_bf16 v[76:91], v[236:239], v[224:227], v[76:91]
    ds_read_b64_tr_b16 v[244:245], v13 offset:45056
    ds_read_b64_tr_b16 v[246:247], v13 offset:47104
    v_mfma_f32_32x32x16_bf16 v[44:59], v[220:223], v[108:111], v[44:59]
    ds_read_b64_tr_b16 v[224:225], v11 offset:12288
    ds_read_b64_tr_b16 v[226:227], v11 offset:14336
    v_mfma_f32_32x32x16_bf16 v[60:75], v[148:151], v[124:127], v[60:75]
    s_waitcnt lgkmcnt(2)
    v_mfma_f32_32x32x16_bf16 v[92:107], v[180:183], v[216:219], v[92:107]
    ds_read_b64_tr_b16 v[236:237], v12 offset:57344
    ds_read_b64_tr_b16 v[238:239], v12 offset:59392
    v_mfma_f32_32x32x16_bf16 v[76:91], v[164:167], v[184:187], v[76:91]
    ds_read_b64_tr_b16 v[116:117], v8 offset:24576
    ds_read_b64_tr_b16 v[118:119], v8 offset:26624
    v_mfma_f32_32x32x16_bf16 v[44:59], v[228:231], v[112:115], v[44:59]
    ds_read_b64_tr_b16 v[180:181], v13 offset:49152
    ds_read_b64_tr_b16 v[182:183], v13 offset:51200
    v_mfma_f32_32x32x16_bf16 v[60:75], v[244:247], v[128:131], v[60:75]
    ds_read_b64_tr_b16 v[164:165], v9 offset:0
    ds_read_b64_tr_b16 v[166:167], v9 offset:2048
    v_smfmac_f32_16x16x64_bf16 v[40:43], v[32:35], v[108:115], v36
    ds_read_b64_tr_b16 v[184:185], v12 offset:61440
    ds_read_b64_tr_b16 v[186:187], v12 offset:63488
    s_waitcnt lgkmcnt(4)
    v_mfma_f32_32x32x16_bf16 v[92:107], v[168:171], v[224:227], v[92:107]
    ds_read_b64_tr_b16 v[120:121], v8 offset:28672
    ds_read_b64_tr_b16 v[122:123], v8 offset:30720
    v_mfma_f32_32x32x16_bf16 v[76:91], v[136:139], v[156:159], v[76:91]
    ds_read_b64_tr_b16 v[168:169], v13 offset:53248
    ds_read_b64_tr_b16 v[170:171], v13 offset:55296
    v_mfma_f32_32x32x16_bf16 v[44:59], v[236:239], v[116:119], v[44:59]
    ds_read_b64_tr_b16 v[136:137], v9 offset:4096
    ds_read_b64_tr_b16 v[138:139], v9 offset:6144
    v_mfma_f32_32x32x16_bf16 v[60:75], v[180:183], v[108:111], v[60:75]
    s_waitcnt lgkmcnt(2)
    v_mfma_f32_32x32x16_bf16 v[92:107], v[208:211], v[164:167], v[92:107]
    s_barrier
    ds_read_b64_tr_b16 v[156:157], v14 offset:0
    ds_read_b64_tr_b16 v[158:159], v14 offset:2048
    v_mfma_f32_32x32x16_bf16 v[76:91], v[160:163], v[132:135], v[76:91]
    ds_read_b64_tr_b16 v[124:125], v8 offset:32768
    ds_read_b64_tr_b16 v[126:127], v8 offset:34816
    v_mfma_f32_32x32x16_bf16 v[44:59], v[184:187], v[120:123], v[44:59]
    ds_read_b64_tr_b16 v[208:209], v13 offset:57344
    ds_read_b64_tr_b16 v[210:211], v13 offset:59392
    v_mfma_f32_32x32x16_bf16 v[60:75], v[168:171], v[112:115], v[60:75]
    ds_read_b64_tr_b16 v[132:133], v9 offset:8192
    ds_read_b64_tr_b16 v[134:135], v9 offset:10240
    v_smfmac_f32_16x16x64_bf16 v[40:43], v[32:35], v[116:123], v36
    ds_read_b64_tr_b16 v[160:161], v14 offset:4096
    ds_read_b64_tr_b16 v[162:163], v14 offset:6144
    s_waitcnt lgkmcnt(4)
    v_mfma_f32_32x32x16_bf16 v[92:107], v[176:179], v[136:139], v[92:107]
    ds_read_b64_tr_b16 v[128:129], v8 offset:36864
    ds_read_b64_tr_b16 v[130:131], v8 offset:38912
    v_mfma_f32_32x32x16_bf16 v[76:91], v[140:143], v[152:155], v[76:91]
    ds_read_b64_tr_b16 v[176:177], v13 offset:61440
    ds_read_b64_tr_b16 v[178:179], v13 offset:63488
    v_mfma_f32_32x32x16_bf16 v[44:59], v[156:159], v[124:127], v[44:59]
    ds_read_b64_tr_b16 v[140:141], v9 offset:12288
    ds_read_b64_tr_b16 v[142:143], v9 offset:14336
    v_mfma_f32_32x32x16_bf16 v[60:75], v[208:211], v[116:119], v[60:75]
    s_waitcnt lgkmcnt(2)
    v_mfma_f32_32x32x16_bf16 v[92:107], v[148:151], v[132:135], v[92:107]
    ds_read_b64_tr_b16 v[152:153], v14 offset:8192
    ds_read_b64_tr_b16 v[154:155], v14 offset:10240
    v_mfma_f32_32x32x16_bf16 v[76:91], v[200:203], v[172:175], v[76:91]
    ds_read_b64_tr_b16 v[108:109], v8 offset:40960
    ds_read_b64_tr_b16 v[110:111], v8 offset:43008
    v_mfma_f32_32x32x16_bf16 v[44:59], v[160:163], v[128:131], v[44:59]
    ds_read_b64_tr_b16 v[148:149], v15 offset:0
    ds_read_b64_tr_b16 v[150:151], v15 offset:2048
    v_mfma_f32_32x32x16_bf16 v[60:75], v[176:179], v[120:123], v[60:75]
    ds_read_b64_tr_b16 v[172:173], v9 offset:16384
    ds_read_b64_tr_b16 v[174:175], v9 offset:18432
    v_smfmac_f32_16x16x64_bf16 v[40:43], v[32:35], v[124:131], v36
    ds_read_b64_tr_b16 v[200:201], v14 offset:12288
    ds_read_b64_tr_b16 v[202:203], v14 offset:14336
    s_waitcnt lgkmcnt(4)
    v_mfma_f32_32x32x16_bf16 v[92:107], v[244:247], v[140:143], v[92:107]
    ds_read_b64_tr_b16 v[112:113], v8 offset:45056
    ds_read_b64_tr_b16 v[114:115], v8 offset:47104
    v_mfma_f32_32x32x16_bf16 v[76:91], v[144:147], v[188:191], v[76:91]
    ds_read_b64_tr_b16 v[244:245], v15 offset:4096
    ds_read_b64_tr_b16 v[246:247], v15 offset:6144
    v_mfma_f32_32x32x16_bf16 v[44:59], v[152:155], v[108:111], v[44:59]
    ds_read_b64_tr_b16 v[144:145], v9 offset:20480
    ds_read_b64_tr_b16 v[146:147], v9 offset:22528
    v_mfma_f32_32x32x16_bf16 v[60:75], v[148:151], v[124:127], v[60:75]
    s_waitcnt lgkmcnt(2)
    v_mfma_f32_32x32x16_bf16 v[92:107], v[180:183], v[172:175], v[92:107]
    ds_read_b64_tr_b16 v[188:189], v15 offset:8192
    ds_read_b64_tr_b16 v[190:191], v15 offset:10240
    v_mfma_f32_32x32x16_bf16 v[76:91], v[232:235], v[216:219], v[76:91]
    ds_read_b64_tr_b16 v[180:181], v9 offset:24576
    ds_read_b64_tr_b16 v[182:183], v9 offset:26624
    v_mfma_f32_32x32x16_bf16 v[44:59], v[200:203], v[112:115], v[44:59]
    v_mfma_f32_32x32x16_bf16 v[60:75], v[244:247], v[128:131], v[60:75]
    v_smfmac_f32_16x16x64_bf16 v[40:43], v[32:35], v[108:115], v36
    ds_read_b64_tr_b16 v[216:217], v15 offset:12288
    ds_read_b64_tr_b16 v[218:219], v15 offset:14336
    s_waitcnt lgkmcnt(2)
    v_mfma_f32_32x32x16_bf16 v[92:107], v[168:171], v[144:147], v[92:107]
    ds_read_b64_tr_b16 v[232:233], v9 offset:28672
    ds_read_b64_tr_b16 v[234:235], v9 offset:30720
    v_mfma_f32_32x32x16_bf16 v[76:91], v[240:243], v[224:227], v[76:91]
    v_mfma_f32_32x32x16_bf16 v[60:75], v[188:191], v[108:111], v[60:75]
    v_add_f32 v40, v40, v42
    v_add_f32 v41, v41, v43
    v_cndmask_b32 v40, v41, v40, s[62:63]
    v_mul_f32 v40, 0xbb000000, v40
    v_cvt_pk_bf16_f32 v24, v40, v40
    v_cvt_pk_bf16_f32 v25, v40, v40
    v_mfma_f32_32x32x16_bf16 v[92:107], v[208:211], v[180:183], v[92:107]
    ds_read_b64_tr_b16 v[168:169], v9 offset:32768
    ds_read_b64_tr_b16 v[170:171], v9 offset:34816
    ds_write_b32 v7, v24
    v_mfma_f32_32x32x16_bf16 v[76:91], v[192:195], v[164:167], v[76:91]
    s_nop 1
    v_mfma_f32_32x32x16_bf16 v[44:59], v[16:19], v[24:27], v[44:59]
    ds_read_b64_tr_b16 v[224:225], v9 offset:36864
    ds_read_b64_tr_b16 v[226:227], v9 offset:38912
    s_waitcnt lgkmcnt(5)
    v_mfma_f32_32x32x16_bf16 v[60:75], v[216:219], v[112:115], v[60:75]
    v_mfma_f32_32x32x16_bf16 v[92:107], v[176:179], v[232:235], v[92:107]
    s_waitcnt lgkmcnt(2)
    s_barrier
    ds_read2_b32 v[28:29], v37 offset0:0 offset1:0
    ds_read_b64_tr_b16 v[240:241], v9 offset:40960
    v_cvt_pk_bf16_f32 v44, v44, v45
    v_cvt_pk_bf16_f32 v45, v46, v47
    v_cvt_pk_bf16_f32 v46, v48, v49
    v_cvt_pk_bf16_f32 v47, v50, v51
    v_pk_max_i16 v44, v44, 0
    v_mfma_f32_32x32x16_bf16 v[76:91], v[196:199], v[136:139], v[76:91]
    ds_read_b64_tr_b16 v[242:243], v9 offset:43008
    v_pk_max_i16 v45, v45, 0
    v_pk_max_i16 v46, v46, 0
    v_pk_max_i16 v47, v47, 0
    buffer_store_dwordx4 v[44:47], v6, s[12:15], s48 offen sc1
    v_cvt_pk_bf16_f32 v52, v52, v53
    v_cvt_pk_bf16_f32 v53, v54, v55
    v_mfma_f32_32x32x16_bf16 v[60:75], v[20:23], v[24:27], v[60:75]
    ds_read_b64_tr_b16 v[208:209], v9 offset:45056
    ds_read_b64_tr_b16 v[210:211], v9 offset:47104
    v_cvt_pk_bf16_f32 v54, v56, v57
    v_cvt_pk_bf16_f32 v55, v58, v59
    v_pk_max_i16 v52, v52, 0
    v_pk_max_i16 v53, v53, 0
    v_mfma_f32_32x32x16_bf16 v[92:107], v[148:151], v[168:171], v[92:107]
    v_pk_max_i16 v54, v54, 0
    v_pk_max_i16 v55, v55, 0
    buffer_store_dwordx4 v[52:55], v6, s[12:15], s49 offen sc1
    v_mfma_f32_32x32x16_bf16 v[76:91], v[204:207], v[132:135], v[76:91]
    s_waitcnt lgkmcnt(2)
    v_mfma_f32_32x32x16_bf16 v[92:107], v[244:247], v[224:227], v[92:107]
    v_cvt_pk_bf16_f32 v60, v60, v61
    v_cvt_pk_bf16_f32 v61, v62, v63
    v_cvt_pk_bf16_f32 v62, v64, v65
    v_cvt_pk_bf16_f32 v63, v66, v67
    v_pk_max_i16 v60, v60, 0
    v_pk_max_i16 v61, v61, 0
    v_pk_max_i16 v62, v62, 0
    v_mfma_f32_32x32x16_bf16 v[76:91], v[212:215], v[140:143], v[76:91]
    v_pk_max_i16 v63, v63, 0
    buffer_store_dwordx4 v[60:63], v6, s[12:15], s50 offen sc1
    v_cvt_pk_bf16_f32 v68, v68, v69
    v_cvt_pk_bf16_f32 v69, v70, v71
    v_cvt_pk_bf16_f32 v70, v72, v73
    v_cvt_pk_bf16_f32 v71, v74, v75
    v_mfma_f32_32x32x16_bf16 v[92:107], v[188:191], v[240:243], v[92:107]
    v_pk_max_i16 v68, v68, 0
    v_pk_max_i16 v69, v69, 0
    v_pk_max_i16 v70, v70, 0
    v_pk_max_i16 v71, v71, 0
    buffer_store_dwordx4 v[68:71], v6, s[12:15], s51 offen sc1
    v_mfma_f32_32x32x16_bf16 v[76:91], v[220:223], v[172:175], v[76:91]
    s_waitcnt lgkmcnt(0)
    v_mfma_f32_32x32x16_bf16 v[92:107], v[216:219], v[208:211], v[92:107]
    v_mfma_f32_32x32x16_bf16 v[76:91], v[228:231], v[144:147], v[76:91]
    v_mfma_f32_32x32x16_bf16 v[92:107], v[20:23], v[28:31], v[92:107]
    v_mfma_f32_32x32x16_bf16 v[76:91], v[236:239], v[180:183], v[76:91]
    v_mfma_f32_32x32x16_bf16 v[76:91], v[184:187], v[232:235], v[76:91]
    v_mfma_f32_32x32x16_bf16 v[76:91], v[156:159], v[168:171], v[76:91]
    v_cvt_pk_bf16_f32 v92, v92, v93
    v_cvt_pk_bf16_f32 v93, v94, v95
    v_cvt_pk_bf16_f32 v94, v96, v97
    v_cvt_pk_bf16_f32 v95, v98, v99
    v_pk_max_i16 v92, v92, 0
    v_pk_max_i16 v93, v93, 0
    v_pk_max_i16 v94, v94, 0
    v_mfma_f32_32x32x16_bf16 v[76:91], v[160:163], v[224:227], v[76:91]
    v_pk_max_i16 v95, v95, 0
    buffer_store_dwordx4 v[92:95], v6, s[12:15], s54 offen sc1
    v_cvt_pk_bf16_f32 v100, v100, v101
    v_cvt_pk_bf16_f32 v101, v102, v103
    v_cvt_pk_bf16_f32 v102, v104, v105
    v_cvt_pk_bf16_f32 v103, v106, v107
    v_mfma_f32_32x32x16_bf16 v[76:91], v[152:155], v[240:243], v[76:91]
    v_pk_max_i16 v100, v100, 0
    v_pk_max_i16 v101, v101, 0
    v_pk_max_i16 v102, v102, 0
    v_pk_max_i16 v103, v103, 0
    buffer_store_dwordx4 v[100:103], v6, s[12:15], s55 offen sc1
    v_mfma_f32_32x32x16_bf16 v[76:91], v[200:203], v[208:211], v[76:91]
    v_mfma_f32_32x32x16_bf16 v[76:91], v[16:19], v[28:31], v[76:91]
    s_nop 11
    v_cvt_pk_bf16_f32 v76, v76, v77
    v_cvt_pk_bf16_f32 v77, v78, v79
    v_cvt_pk_bf16_f32 v78, v80, v81
    v_cvt_pk_bf16_f32 v79, v82, v83
    v_pk_max_i16 v76, v76, 0
    v_pk_max_i16 v77, v77, 0
    v_pk_max_i16 v78, v78, 0
    v_pk_max_i16 v79, v79, 0
    buffer_store_dwordx4 v[76:79], v6, s[12:15], s52 offen sc1
    v_cvt_pk_bf16_f32 v84, v84, v85
    v_cvt_pk_bf16_f32 v85, v86, v87
    v_cvt_pk_bf16_f32 v86, v88, v89
    v_cvt_pk_bf16_f32 v87, v90, v91
    v_pk_max_i16 v84, v84, 0
    v_pk_max_i16 v85, v85, 0
    v_pk_max_i16 v86, v86, 0
    v_pk_max_i16 v87, v87, 0
    buffer_store_dwordx4 v[84:87], v6, s[12:15], s53 offen sc1
    s_barrier
    s_branch K4_COMPUTE
K3_END:
    s_endpgm
K4_LV0:
    s_waitcnt vmcnt(0)
K4_LV4:
    s_mov_b32 s84, s34
    s_mov_b32 s85, s35
    s_mov_b32 s86, 0x1c0000
    s_mov_b32 s87, 0x00020000
    v_add_u32 v29, s62, v246
    v_add_u32 v30, 0x10000, v29
    v_add_u32 v31, 0x20000, v29
    s_waitcnt vmcnt(21)
    ds_write_b128 v31, v[96:99] offset:0
    ds_write_b128 v31, v[100:103] offset:1024
    ds_write_b128 v31, v[104:107] offset:2048
    ds_write_b128 v31, v[108:111] offset:3072
    ds_write_b128 v31, v[112:115] offset:16384
    ds_write_b128 v31, v[116:119] offset:17408
    ds_write_b128 v31, v[120:123] offset:18432
    ds_write_b128 v31, v[124:127] offset:19456
    s_add_u32 s69, s60, 1310720
    buffer_load_dwordx4 v[192:195], v241, s[84:87], s69 offen offset:0
    buffer_load_dwordx4 v[196:199], v242, s[84:87], s69 offen offset:1024
    buffer_load_dwordx4 v[200:203], v243, s[84:87], s69 offen offset:2048
    buffer_load_dwordx4 v[204:207], v244, s[84:87], s69 offen offset:3072
    ds_write_b128 v29, v[128:131] offset:0
    ds_write_b128 v29, v[132:135] offset:1024
    ds_write_b128 v29, v[136:139] offset:2048
    ds_write_b128 v29, v[140:143] offset:3072
    ds_write_b128 v29, v[144:147] offset:16384
    ds_write_b128 v29, v[148:151] offset:17408
    ds_write_b128 v29, v[152:155] offset:18432
    ds_write_b128 v29, v[156:159] offset:19456
    s_add_u32 s69, s60, 1441792
    buffer_load_dwordx4 v[208:211], v241, s[84:87], s69 offen offset:0
    buffer_load_dwordx4 v[212:215], v242, s[84:87], s69 offen offset:1024
    buffer_load_dwordx4 v[216:219], v243, s[84:87], s69 offen offset:2048
    buffer_load_dwordx4 v[220:223], v244, s[84:87], s69 offen offset:3072
    ds_write_b128 v30, v[160:163] offset:0
    ds_write_b128 v30, v[164:167] offset:1024
    ds_write_b128 v30, v[168:171] offset:2048
    ds_write_b128 v30, v[172:175] offset:3072
    ds_write_b128 v29, v[176:179] offset:32768
    ds_write_b128 v29, v[180:183] offset:33792
    ds_write_b128 v29, v[184:187] offset:34816
    ds_write_b128 v29, v[188:191] offset:35840
    s_add_u32 s69, s60, 1572864
    buffer_load_dwordx4 v[72:75], v241, s[84:87], s69 offen offset:0
    buffer_load_dwordx4 v[76:79], v242, s[84:87], s69 offen offset:1024
    buffer_load_dwordx4 v[80:83], v243, s[84:87], s69 offen offset:2048
    buffer_load_dwordx4 v[84:87], v244, s[84:87], s69 offen offset:3072
    s_waitcnt vmcnt(12) lgkmcnt(0)
    s_barrier
    s_barrier
    s_waitcnt vmcnt(8)
    ds_write_b128 v30, v[192:195] offset:16384
    ds_write_b128 v30, v[196:199] offset:17408
    ds_write_b128 v30, v[200:203] offset:18432
    ds_write_b128 v30, v[204:207] offset:19456
    s_waitcnt lgkmcnt(0)
    s_barrier
    s_waitcnt vmcnt(4)
    ds_write_b128 v30, v[208:211] offset:32768
    ds_write_b128 v30, v[212:215] offset:33792
    ds_write_b128 v30, v[216:219] offset:34816
    ds_write_b128 v30, v[220:223] offset:35840
    s_waitcnt lgkmcnt(0)
    s_barrier
    s_waitcnt vmcnt(0)
    ds_write_b128 v29, v[72:75] offset:49152
    ds_write_b128 v29, v[76:79] offset:50176
    ds_write_b128 v29, v[80:83] offset:51200
    ds_write_b128 v29, v[84:87] offset:52224
    s_add_u32 m0, s62, 114688
    s_add_u32 s69, s60, 1703936
    buffer_load_dwordx4 v241, s[84:87], s69 offen offset:0 lds
    buffer_load_dwordx4 v242, s[84:87], s69 offen offset:1024 lds
    buffer_load_dwordx4 v243, s[84:87], s69 offen offset:2048 lds
    buffer_load_dwordx4 v244, s[84:87], s69 offen offset:3072 lds
    s_add_u32 m0, s64, 131072
    s_add_u32 s69, s63, 0
    buffer_load_dwordx4 v245, s[12:15], s69 offen sc1 lds
    s_add_u32 m0, s64, 132096
    s_add_u32 s69, s63, 2048
    buffer_load_dwordx4 v245, s[12:15], s69 offen sc1 lds
    s_waitcnt lgkmcnt(0)
    s_barrier
    s_waitcnt vmcnt(0)
    s_barrier
    s_endpgm
K4_COMPUTE:
    s_setprio 3
    s_lshr_b32 s4, s2, 3
    s_lshr_b32 s3, s4, 3
    s_and_b32 s4, s4, 7
    s_and_b32 s6, s2, 7
    s_lshl2_add_u32 s3, s6, s3
    s_and_b32 s6, s5, 1
    s_lshr_b32 s7, s5, 1
    v_lshrrev_b32 v3, 5, v1
    v_bfe_u32 v4, v1, 2, 2
    v_bfe_u32 v5, v1, 4, 1
    v_lshlrev_b32 v5, 5, v5
    v_lshl_add_u32 v5, v4, 7, v5
    v_bfe_u32 v6, v1, 3, 1
    v_and_b32 v7, 1, v1
    v_bfe_u32 v12, v1, 1, 1
    v_lshl_add_u32 v12, v7, 1, v12
    v_xor_b32 v7, s6, v6
    v_lshl_add_u32 v8, v7, 6, v5
    v_lshl_add_u32 v8, v12, 3, v8
    v_lshl_add_u32 v8, v3, 9, v8
    v_lshl_add_u32 v8, s6, 13, v8
    v_add_u32 v9, 0x10000, v8
    v_add_u32 v10, 0x20000, v8
    v_xor_b32 v7, s7, v6
    v_lshl_add_u32 v12, v7, 6, v5
    v_and_b32 v7, 3, v1
    v_lshl_add_u32 v12, v7, 3, v12
    v_lshl_add_u32 v12, v3, 10, v12
    s_lshl_b32 s44, s6, 12
    s_add_u32 s44, s44, 131072
    v_add_u32 v12, s44, v12
    v_lshlrev_b32 v16, 4, v1
    v_xor_b32 v20, 64, v8
    v_xor_b32 v21, 64, v9
    v_xor_b32 v22, 64, v10
    v_lshlrev_b32 v247, 7, v1
    s_lshl_b32 s44, s5, 12
    s_add_u32 s44, s44, 147456
    v_add_u32 v15, s44, v16
    v_xor_b32 v17, 0x1000, v15
    v_lshlrev_b32 v14, 4, v3
    v_xor_b32 v14, v14, v17
    v_xor_b32 v19, 32, v14
    v_and_b32 v25, 3, v1
    v_lshlrev_b32 v23, 1, v3
    v_xor_b32 v25, v23, v25
    v_and_b32 v23, 28, v1
    v_add_u32 v25, v23, v25
    v_lshlrev_b32 v25, 4, v25
    v_and_b32 v23, 1, v1
    v_lshl_add_u32 v25, v23, 9, v25
    v_and_b32 v23, 2, v1
    v_lshl_add_u32 v25, v23, 9, v25
    s_xor_b32 s44, s44, 0x1000
    v_add_u32 v25, s44, v25
    v_xor_b32 v23, 16, v25
    s_lshl_b32 s61, s3, 1
    s_add_u32 s61, s61, s7
    s_xor_b32 s62, s61, 0
    s_mul_i32 s62, s62, 66048
    s_mul_i32 s61, s61, 114688
    s_lshl_b32 s44, s6, 12
    s_add_u32 s61, s61, s44
    s_add_u32 s61, s61, 0x600000
    s_add_u32 s62, s62, s44
    s_add_u32 s62, s62, 0x1000000
    s_lshl_b32 s65, s3, 12
    s_add_u32 s65, s65, 0x560000
    v_and_b32 v4, 31, v1
    v_lshlrev_b32 v6, 4, v3
    v_lshl_add_u32 v6, v4, 10, v6
    v_and_b32 v7, 28, v1
    v_lshl_add_u32 v7, v3, 1, v7
    v_and_b32 v6, 3, v1
    v_lshlrev_b32 v6, 4, v6
    v_lshl_add_u32 v6, v7, 10, v6
    v_lshlrev_b32 v4, 2, v4
    s_lshl_b32 s47, s3, 16
    s_lshl_b32 s48, s7, 15
    s_add_u32 s47, s47, s48
    s_lshl_b32 s48, s4, 7
    s_add_u32 s47, s47, s48
    s_lshl_b32 s48, s6, 6
    s_add_u32 s47, s47, s48
    s_lshl_b32 s55, s3, 8
    s_lshl_b32 s50, s7, 7
    s_add_u32 s55, s55, s50
    s_add_u32 s55, s55, 0x548000
    s_mov_b32 s56, s36
    s_mov_b32 s57, s37
    s_mov_b32 s58, 0x200000
    s_mov_b32 s59, 0x00020000
    v_mov_b32 v13, 1
    s_waitcnt vmcnt(0)
    s_cmp_eq_u32 s43, 0
    s_cbranch_scc1 K4_NOFLAG
    s_mov_b64 exec, 0x1
    buffer_store_dword v13, off, s[12:15], s43 sc1
    s_mov_b64 exec, -1
K4_NOFLAG:
    v_mov_b32 v24, 0
    s_mov_b32 s66, 0
    s_mov_b32 s67, 0
    s_mov_b32 s68, 0
    s_barrier
    s_add_u32 s69, s62, 0
    buffer_load_dwordx4 v[96:99], v16, s[12:15], s69 offen offset:0 sc1
    buffer_load_dwordx4 v[100:103], v16, s[12:15], s69 offen offset:1024 sc1
    buffer_load_dwordx4 v[104:107], v16, s[12:15], s69 offen offset:2048 sc1
    buffer_load_dwordx4 v[108:111], v16, s[12:15], s69 offen offset:3072 sc1
    s_add_u32 s69, s62, 8192
    buffer_load_dwordx4 v[112:115], v16, s[12:15], s69 offen offset:0 sc1
    buffer_load_dwordx4 v[116:119], v16, s[12:15], s69 offen offset:1024 sc1
    buffer_load_dwordx4 v[120:123], v16, s[12:15], s69 offen offset:2048 sc1
    buffer_load_dwordx4 v[124:127], v16, s[12:15], s69 offen offset:3072 sc1
    s_add_u32 s69, s62, 16512
    buffer_load_dwordx4 v[128:131], v16, s[12:15], s69 offen offset:0 sc1
    buffer_load_dwordx4 v[132:135], v16, s[12:15], s69 offen offset:1024 sc1
    ds_read_b64_tr_b16 v[68:69], v21 offset:16384
    ds_read_b64_tr_b16 v[70:71], v21 offset:17408
    ds_read_b64_tr_b16 v[64:65], v9 offset:16384
    ds_read_b64_tr_b16 v[66:67], v9 offset:17408
    ds_read_b64_tr_b16 v[76:77], v21 offset:18432
    ds_read_b64_tr_b16 v[78:79], v21 offset:19456
    ds_read_b64_tr_b16 v[72:73], v9 offset:18432
    ds_read_b64_tr_b16 v[74:75], v9 offset:19456
    ds_read_b64_tr_b16 v[84:85], v21 offset:20480
    ds_read_b64_tr_b16 v[86:87], v21 offset:21504
    ds_read_b64_tr_b16 v[80:81], v9 offset:20480
    ds_read_b64_tr_b16 v[82:83], v9 offset:21504
    s_waitcnt vmcnt(9) lgkmcnt(8)
    v_cmp_gt_i32 vcc, 0, v98
    s_nop 0
    s_cbranch_vccnz K4_R0
K4_D0:
    v_mfma_f32_32x32x16_bf16 v[48:63], v[68:71], v[96:99], 0
    ds_read_b64_tr_b16 v[92:93], v21 offset:22528
    ds_read_b64_tr_b16 v[94:95], v21 offset:23552
    v_mfma_f32_32x32x16_bf16 v[32:47], v[64:67], v[96:99], 0
    s_waitcnt vmcnt(8)
    v_cmp_gt_i32 vcc, 0, v102
    ds_read_b64_tr_b16 v[88:89], v9 offset:22528
    ds_read_b64_tr_b16 v[90:91], v9 offset:23552
    s_cbranch_vccnz K4_R1
K4_D1:
    buffer_load_dwordx4 v[96:99], v16, s[12:15], s69 offen offset:2048 sc1
    s_waitcnt vmcnt(9) lgkmcnt(8)
    v_mfma_f32_32x32x16_bf16 v[48:63], v[76:79], v[100:103], v[48:63]
    ds_read_b64_tr_b16 v[68:69], v21 offset:32768
    ds_read_b64_tr_b16 v[70:71], v21 offset:33792
    v_mfma_f32_32x32x16_bf16 v[32:47], v[72:75], v[100:103], v[32:47]
    s_waitcnt vmcnt(8)
    v_cmp_gt_i32 vcc, 0, v106
    ds_read_b64_tr_b16 v[64:65], v9 offset:32768
    ds_read_b64_tr_b16 v[66:67], v9 offset:33792
    s_cbranch_vccnz K4_R2
K4_D2:
    buffer_load_dwordx4 v[100:103], v16, s[12:15], s69 offen offset:3072 sc1
    s_waitcnt vmcnt(9) lgkmcnt(8)
    v_mfma_f32_32x32x16_bf16 v[48:63], v[84:87], v[104:107], v[48:63]
    ds_read_b64_tr_b16 v[76:77], v21 offset:34816
    ds_read_b64_tr_b16 v[78:79], v21 offset:35840
    v_mfma_f32_32x32x16_bf16 v[32:47], v[80:83], v[104:107], v[32:47]
    s_waitcnt vmcnt(8)
    v_cmp_gt_i32 vcc, 0, v110
    ds_read_b64_tr_b16 v[72:73], v9 offset:34816
    ds_read_b64_tr_b16 v[74:75], v9 offset:35840
    s_cbranch_vccnz K4_R3
K4_D3:
    s_mov_b32 exec_lo, 0x1fffffff
    s_mov_b32 exec_hi, 0
    buffer_load_dword v24, v247, s[12:15], s65 offen sc1
    s_mov_b64 exec, -1
    s_add_u32 s69, s62, 24704
    buffer_load_dwordx4 v[104:107], v16, s[12:15], s69 offen offset:0 sc1
    s_waitcnt vmcnt(10) lgkmcnt(8)
    v_mfma_f32_32x32x16_bf16 v[48:63], v[92:95], v[108:111], v[48:63]
    ds_read_b64_tr_b16 v[84:85], v21 offset:36864
    ds_read_b64_tr_b16 v[86:87], v21 offset:37888
    v_mfma_f32_32x32x16_bf16 v[32:47], v[88:91], v[108:111], v[32:47]
    s_waitcnt vmcnt(9)
    v_cmp_gt_i32 vcc, 0, v114
    ds_read_b64_tr_b16 v[80:81], v9 offset:36864
    ds_read_b64_tr_b16 v[82:83], v9 offset:37888
    s_cbranch_vccnz K4_R4
K4_D4:
    buffer_load_dwordx4 v[108:111], v16, s[12:15], s69 offen offset:1024 sc1
    s_waitcnt vmcnt(10) lgkmcnt(8)
    v_mfma_f32_32x32x16_bf16 v[48:63], v[68:71], v[112:115], v[48:63]
    ds_read_b64_tr_b16 v[92:93], v21 offset:38912
    ds_read_b64_tr_b16 v[94:95], v21 offset:39936
    v_mfma_f32_32x32x16_bf16 v[32:47], v[64:67], v[112:115], v[32:47]
    s_waitcnt vmcnt(9)
    v_cmp_gt_i32 vcc, 0, v118
    ds_read_b64_tr_b16 v[88:89], v9 offset:38912
    ds_read_b64_tr_b16 v[90:91], v9 offset:39936
    s_cbranch_vccnz K4_R5
K4_D5:
    buffer_load_dwordx4 v[112:115], v16, s[12:15], s69 offen offset:2048 sc1
    s_waitcnt vmcnt(10) lgkmcnt(8)
    v_mfma_f32_32x32x16_bf16 v[48:63], v[76:79], v[116:119], v[48:63]
    ds_read_b64_tr_b16 v[68:69], v20 offset:49152
    ds_read_b64_tr_b16 v[70:71], v20 offset:50176
    v_mfma_f32_32x32x16_bf16 v[32:47], v[72:75], v[116:119], v[32:47]
    s_waitcnt vmcnt(9)
    v_cmp_gt_i32 vcc, 0, v122
    ds_read_b64_tr_b16 v[64:65], v8 offset:49152
    ds_read_b64_tr_b16 v[66:67], v8 offset:50176
    s_cbranch_vccnz K4_R6
K4_D6:
    buffer_load_dwordx4 v[116:119], v16, s[12:15], s69 offen offset:3072 sc1
    s_waitcnt vmcnt(10) lgkmcnt(8)
    v_mfma_f32_32x32x16_bf16 v[48:63], v[84:87], v[120:123], v[48:63]
    ds_read_b64_tr_b16 v[76:77], v20 offset:51200
    ds_read_b64_tr_b16 v[78:79], v20 offset:52224
    v_mfma_f32_32x32x16_bf16 v[32:47], v[80:83], v[120:123], v[32:47]
    s_waitcnt vmcnt(9)
    v_cmp_gt_i32 vcc, 0, v126
    ds_read_b64_tr_b16 v[72:73], v8 offset:51200
    ds_read_b64_tr_b16 v[74:75], v8 offset:52224
    s_cbranch_vccnz K4_R7
K4_D7:
    s_waitcnt vmcnt(9) lgkmcnt(8)
    v_mfma_f32_32x32x16_bf16 v[48:63], v[92:95], v[124:127], v[48:63]
    ds_read_b64_tr_b16 v[84:85], v20 offset:53248
    ds_read_b64_tr_b16 v[86:87], v20 offset:54272
    v_mfma_f32_32x32x16_bf16 v[32:47], v[88:91], v[124:127], v[32:47]
    s_waitcnt vmcnt(8)
    v_cmp_gt_i32 vcc, 0, v130
    ds_read_b64_tr_b16 v[80:81], v8 offset:53248
    ds_read_b64_tr_b16 v[82:83], v8 offset:54272
    s_cbranch_vccnz K4_R8
K4_D8:
    s_waitcnt vmcnt(8) lgkmcnt(8)
    v_mfma_f32_32x32x16_bf16 v[48:63], v[68:71], v[128:131], v[48:63]
    ds_read_b64_tr_b16 v[92:93], v20 offset:55296
    ds_read_b64_tr_b16 v[94:95], v20 offset:56320
    v_mfma_f32_32x32x16_bf16 v[32:47], v[64:67], v[128:131], v[32:47]
    s_waitcnt vmcnt(7)
    v_cmp_gt_i32 vcc, 0, v134
    ds_read_b64_tr_b16 v[88:89], v8 offset:55296
    ds_read_b64_tr_b16 v[90:91], v8 offset:56320
    s_cbranch_vccnz K4_R9
K4_D9:
    s_waitcnt vmcnt(7) lgkmcnt(8)
    v_mfma_f32_32x32x16_bf16 v[48:63], v[76:79], v[132:135], v[48:63]
    ds_read_b64_tr_b16 v[68:69], v21 offset:49152
    ds_read_b64_tr_b16 v[70:71], v21 offset:50176
    v_mfma_f32_32x32x16_bf16 v[32:47], v[72:75], v[132:135], v[32:47]
    s_waitcnt vmcnt(6)
    v_cmp_gt_i32 vcc, 0, v98
    ds_read_b64_tr_b16 v[64:65], v9 offset:49152
    ds_read_b64_tr_b16 v[66:67], v9 offset:50176
    s_cbranch_vccnz K4_R10
K4_D10:
    s_waitcnt vmcnt(6) lgkmcnt(8)
    v_mfma_f32_32x32x16_bf16 v[48:63], v[84:87], v[96:99], v[48:63]
    ds_read_b64_tr_b16 v[76:77], v21 offset:51200
    ds_read_b64_tr_b16 v[78:79], v21 offset:52224
    v_mfma_f32_32x32x16_bf16 v[32:47], v[80:83], v[96:99], v[32:47]
    s_waitcnt vmcnt(5)
    v_cmp_gt_i32 vcc, 0, v102
    ds_read_b64_tr_b16 v[72:73], v9 offset:51200
    ds_read_b64_tr_b16 v[74:75], v9 offset:52224
    s_cbranch_vccnz K4_R11
K4_D11:
    s_waitcnt vmcnt(4)
    v_cmp_eq_u32 vcc, 1, v24
    s_and_b32 s66, s5, 1
    s_mov_b32 s67, vcc_lo
    s_lshr_b32 s66, s67, s66
K4_PS4:
    s_bitcmp1_b32 s66, 8
    s_cbranch_scc1 K4_QS4
    s_add_u32 s68, s68, 1
    s_cmp_gt_u32 s68, 131072
    s_cbranch_scc1 K4_QS4
    s_mov_b32 exec_lo, 0x1fffffff
    s_mov_b32 exec_hi, 0
    buffer_load_dword v24, v247, s[12:15], s65 offen sc1
    s_mov_b64 exec, -1
    s_waitcnt vmcnt(0)
    v_cmp_eq_u32 vcc, 1, v24
    s_and_b32 s66, s5, 1
    s_mov_b32 s67, vcc_lo
    s_lshr_b32 s66, s67, s66
    s_branch K4_PS4
K4_QS4:
    s_add_u32 s69, s61, 32768
    buffer_load_dwordx4 v[120:123], v16, s[12:15], s69 offen offset:0 sc1
    buffer_load_dwordx4 v[124:127], v16, s[12:15], s69 offen offset:1024 sc1
    buffer_load_dwordx4 v[128:131], v16, s[12:15], s69 offen offset:2048 sc1
    buffer_load_dwordx4 v[132:135], v16, s[12:15], s69 offen offset:3072 sc1
K4_PS5:
    s_bitcmp1_b32 s66, 10
    s_cbranch_scc1 K4_QS5
    s_add_u32 s68, s68, 1
    s_cmp_gt_u32 s68, 131072
    s_cbranch_scc1 K4_QS5
    s_mov_b32 exec_lo, 0x1fffffff
    s_mov_b32 exec_hi, 0
    buffer_load_dword v24, v247, s[12:15], s65 offen sc1
    s_mov_b64 exec, -1
    s_waitcnt vmcnt(0)
    v_cmp_eq_u32 vcc, 1, v24
    s_and_b32 s66, s5, 1
    s_mov_b32 s67, vcc_lo
    s_lshr_b32 s66, s67, s66
    s_branch K4_PS5
K4_QS5:
    s_add_u32 s69, s61, 40960
    buffer_load_dwordx4 v[96:99], v16, s[12:15], s69 offen offset:0 sc1
    s_waitcnt vmcnt(10) lgkmcnt(8)
    v_mfma_f32_32x32x16_bf16 v[48:63], v[92:95], v[100:103], v[48:63]
    ds_read_b64_tr_b16 v[84:85], v21 offset:53248
    ds_read_b64_tr_b16 v[86:87], v21 offset:54272
    v_mfma_f32_32x32x16_bf16 v[32:47], v[88:91], v[100:103], v[32:47]
    s_waitcnt vmcnt(8)
    v_cmp_gt_i32 vcc, 0, v106
    ds_read_b64_tr_b16 v[80:81], v9 offset:53248
    ds_read_b64_tr_b16 v[82:83], v9 offset:54272
    s_cbranch_vccnz K4_R12
K4_D12:
    buffer_load_dwordx4 v[100:103], v16, s[12:15], s69 offen offset:1024 sc1
    s_waitcnt vmcnt(9) lgkmcnt(8)
    v_mfma_f32_32x32x16_bf16 v[48:63], v[68:71], v[104:107], v[48:63]
    ds_read_b64_tr_b16 v[92:93], v21 offset:55296
    ds_read_b64_tr_b16 v[94:95], v21 offset:56320
    v_mfma_f32_32x32x16_bf16 v[32:47], v[64:67], v[104:107], v[32:47]
    s_waitcnt vmcnt(8)
    v_cmp_gt_i32 vcc, 0, v110
    ds_read_b64_tr_b16 v[88:89], v9 offset:55296
    ds_read_b64_tr_b16 v[90:91], v9 offset:56320
    s_cbranch_vccnz K4_R13
K4_D13:
    buffer_load_dwordx4 v[104:107], v16, s[12:15], s69 offen offset:2048 sc1
    s_barrier
    s_waitcnt vmcnt(9) lgkmcnt(8)
    v_mfma_f32_32x32x16_bf16 v[48:63], v[76:79], v[108:111], v[48:63]
    ds_read_b64_tr_b16 v[68:69], v22 offset:0
    ds_read_b64_tr_b16 v[70:71], v22 offset:1024
    v_mfma_f32_32x32x16_bf16 v[32:47], v[72:75], v[108:111], v[32:47]
    s_waitcnt vmcnt(8)
    v_cmp_gt_i32 vcc, 0, v114
    ds_read_b64_tr_b16 v[64:65], v10 offset:0
    ds_read_b64_tr_b16 v[66:67], v10 offset:1024
    s_cbranch_vccnz K4_R14
K4_D14:
    buffer_load_dwordx4 v[108:111], v16, s[12:15], s69 offen offset:3072 sc1
    s_waitcnt vmcnt(9) lgkmcnt(8)
    v_mfma_f32_32x32x16_bf16 v[48:63], v[84:87], v[112:115], v[48:63]
    ds_read_b64_tr_b16 v[76:77], v22 offset:2048
    ds_read_b64_tr_b16 v[78:79], v22 offset:3072
    v_mfma_f32_32x32x16_bf16 v[32:47], v[80:83], v[112:115], v[32:47]
    s_waitcnt vmcnt(8)
    v_cmp_gt_i32 vcc, 0, v118
    ds_read_b64_tr_b16 v[72:73], v10 offset:2048
    ds_read_b64_tr_b16 v[74:75], v10 offset:3072
    s_cbranch_vccnz K4_R15
K4_D15:
K4_PS6:
    s_bitcmp1_b32 s66, 12
    s_cbranch_scc1 K4_QS6
    s_add_u32 s68, s68, 1
    s_cmp_gt_u32 s68, 131072
    s_cbranch_scc1 K4_QS6
    s_mov_b32 exec_lo, 0x1fffffff
    s_mov_b32 exec_hi, 0
    buffer_load_dword v24, v247, s[12:15], s65 offen sc1
    s_mov_b64 exec, -1
    s_waitcnt vmcnt(0)
    v_cmp_eq_u32 vcc, 1, v24
    s_and_b32 s66, s5, 1
    s_mov_b32 s67, vcc_lo
    s_lshr_b32 s66, s67, s66
    s_branch K4_PS6
K4_QS6:
    s_add_u32 s69, s61, 49152
    buffer_load_dwordx4 v[112:115], v16, s[12:15], s69 offen offset:0 sc1
    s_waitcnt vmcnt(9) lgkmcnt(8)
    v_mfma_f32_32x32x16_bf16 v[48:63], v[92:95], v[116:119], v[48:63]
    ds_read_b64_tr_b16 v[84:85], v22 offset:4096
    ds_read_b64_tr_b16 v[86:87], v22 offset:5120
    v_mfma_f32_32x32x16_bf16 v[32:47], v[88:91], v[116:119], v[32:47]
    ds_read_b64_tr_b16 v[80:81], v10 offset:4096
    ds_read_b64_tr_b16 v[82:83], v10 offset:5120
    buffer_load_dwordx4 v[116:119], v16, s[12:15], s69 offen offset:1024 sc1
    s_waitcnt vmcnt(9) lgkmcnt(8)
    v_mfma_f32_32x32x16_bf16 v[48:63], v[68:71], v[120:123], v[48:63]
    ds_read_b64_tr_b16 v[92:93], v22 offset:6144
    ds_read_b64_tr_b16 v[94:95], v22 offset:7168
    v_mfma_f32_32x32x16_bf16 v[32:47], v[64:67], v[120:123], v[32:47]
    ds_read_b64_tr_b16 v[88:89], v10 offset:6144
    ds_read_b64_tr_b16 v[90:91], v10 offset:7168
    buffer_load_dwordx4 v[120:123], v16, s[12:15], s69 offen offset:2048 sc1
    s_waitcnt vmcnt(9) lgkmcnt(8)
    v_mfma_f32_32x32x16_bf16 v[48:63], v[76:79], v[124:127], v[48:63]
    ds_read_b64_tr_b16 v[68:69], v22 offset:16384
    ds_read_b64_tr_b16 v[70:71], v22 offset:17408
    v_mfma_f32_32x32x16_bf16 v[32:47], v[72:75], v[124:127], v[32:47]
    ds_read_b64_tr_b16 v[64:65], v10 offset:16384
    ds_read_b64_tr_b16 v[66:67], v10 offset:17408
    buffer_load_dwordx4 v[124:127], v16, s[12:15], s69 offen offset:3072 sc1
    s_waitcnt vmcnt(9) lgkmcnt(8)
    v_mfma_f32_32x32x16_bf16 v[48:63], v[84:87], v[128:131], v[48:63]
    ds_read_b64_tr_b16 v[76:77], v22 offset:18432
    ds_read_b64_tr_b16 v[78:79], v22 offset:19456
    v_mfma_f32_32x32x16_bf16 v[32:47], v[80:83], v[128:131], v[32:47]
    ds_read_b64_tr_b16 v[72:73], v10 offset:18432
    ds_read_b64_tr_b16 v[74:75], v10 offset:19456
K4_PS7:
    s_bitcmp1_b32 s66, 14
    s_cbranch_scc1 K4_QS7
    s_add_u32 s68, s68, 1
    s_cmp_gt_u32 s68, 131072
    s_cbranch_scc1 K4_QS7
    s_mov_b32 exec_lo, 0x1fffffff
    s_mov_b32 exec_hi, 0
    buffer_load_dword v24, v247, s[12:15], s65 offen sc1
    s_mov_b64 exec, -1
    s_waitcnt vmcnt(0)
    v_cmp_eq_u32 vcc, 1, v24
    s_and_b32 s66, s5, 1
    s_mov_b32 s67, vcc_lo
    s_lshr_b32 s66, s67, s66
    s_branch K4_PS7
K4_QS7:
    s_add_u32 s69, s61, 57344
    buffer_load_dwordx4 v[128:131], v16, s[12:15], s69 offen offset:0 sc1
    s_waitcnt vmcnt(9) lgkmcnt(8)
    v_mfma_f32_32x32x16_bf16 v[48:63], v[92:95], v[132:135], v[48:63]
    ds_read_b64_tr_b16 v[84:85], v22 offset:20480
    ds_read_b64_tr_b16 v[86:87], v22 offset:21504
    v_mfma_f32_32x32x16_bf16 v[32:47], v[88:91], v[132:135], v[32:47]
    ds_read_b64_tr_b16 v[80:81], v10 offset:20480
    ds_read_b64_tr_b16 v[82:83], v10 offset:21504
    buffer_load_dwordx4 v[132:135], v16, s[12:15], s69 offen offset:1024 sc1
    s_waitcnt vmcnt(9) lgkmcnt(8)
    v_mfma_f32_32x32x16_bf16 v[48:63], v[68:71], v[96:99], v[48:63]
    ds_read_b64_tr_b16 v[92:93], v22 offset:22528
    ds_read_b64_tr_b16 v[94:95], v22 offset:23552
    v_mfma_f32_32x32x16_bf16 v[32:47], v[64:67], v[96:99], v[32:47]
    ds_read_b64_tr_b16 v[88:89], v10 offset:22528
    ds_read_b64_tr_b16 v[90:91], v10 offset:23552
    buffer_load_dwordx4 v[96:99], v16, s[12:15], s69 offen offset:2048 sc1
    s_barrier
    s_waitcnt vmcnt(9) lgkmcnt(8)
    v_mfma_f32_32x32x16_bf16 v[48:63], v[76:79], v[100:103], v[48:63]
    ds_read_b64_tr_b16 v[68:69], v20 offset:0
    ds_read_b64_tr_b16 v[70:71], v20 offset:1024
    v_mfma_f32_32x32x16_bf16 v[32:47], v[72:75], v[100:103], v[32:47]
    ds_read_b64_tr_b16 v[64:65], v8 offset:0
    ds_read_b64_tr_b16 v[66:67], v8 offset:1024
    buffer_load_dwordx4 v[100:103], v16, s[12:15], s69 offen offset:3072 sc1
    s_waitcnt vmcnt(9) lgkmcnt(8)
    v_mfma_f32_32x32x16_bf16 v[48:63], v[84:87], v[104:107], v[48:63]
    ds_read_b64_tr_b16 v[76:77], v20 offset:2048
    ds_read_b64_tr_b16 v[78:79], v20 offset:3072
    v_mfma_f32_32x32x16_bf16 v[32:47], v[80:83], v[104:107], v[32:47]
    ds_read_b64_tr_b16 v[72:73], v8 offset:2048
    ds_read_b64_tr_b16 v[74:75], v8 offset:3072
K4_PS8:
    s_bitcmp1_b32 s66, 16
    s_cbranch_scc1 K4_QS8
    s_add_u32 s68, s68, 1
    s_cmp_gt_u32 s68, 131072
    s_cbranch_scc1 K4_QS8
    s_mov_b32 exec_lo, 0x1fffffff
    s_mov_b32 exec_hi, 0
    buffer_load_dword v24, v247, s[12:15], s65 offen sc1
    s_mov_b64 exec, -1
    s_waitcnt vmcnt(0)
    v_cmp_eq_u32 vcc, 1, v24
    s_and_b32 s66, s5, 1
    s_mov_b32 s67, vcc_lo
    s_lshr_b32 s66, s67, s66
    s_branch K4_PS8
K4_QS8:
K4_PR:
    s_bitcmp1_b32 s67, 28
    s_cbranch_scc1 K4_QR
    s_add_u32 s68, s68, 1
    s_cmp_gt_u32 s68, 131072
    s_cbranch_scc1 K4_QR
    s_mov_b32 exec_lo, 0x1fffffff
    s_mov_b32 exec_hi, 0
    buffer_load_dword v24, v247, s[12:15], s65 offen sc1
    s_mov_b64 exec, -1
    s_waitcnt vmcnt(0)
    v_cmp_eq_u32 vcc, 1, v24
    s_and_b32 s66, s5, 1
    s_mov_b32 s67, vcc_lo
    s_lshr_b32 s66, s67, s66
    s_branch K4_PR
K4_QR:
    buffer_load_dword v18, v4, s[12:15], s55 offen sc1
    s_add_u32 s69, s61, 65536
    buffer_load_dwordx4 v[104:107], v16, s[12:15], s69 offen offset:0 sc1
    s_waitcnt vmcnt(10) lgkmcnt(8)
    v_mfma_f32_32x32x16_bf16 v[48:63], v[92:95], v[108:111], v[48:63]
    ds_read_b64_tr_b16 v[84:85], v20 offset:4096
    ds_read_b64_tr_b16 v[86:87], v20 offset:5120
    v_mfma_f32_32x32x16_bf16 v[32:47], v[88:91], v[108:111], v[32:47]
    ds_read_b64_tr_b16 v[80:81], v8 offset:4096
    ds_read_b64_tr_b16 v[82:83], v8 offset:5120
    buffer_load_dwordx4 v[108:111], v16, s[12:15], s69 offen offset:1024 sc1
    s_waitcnt vmcnt(10) lgkmcnt(8)
    v_mfma_f32_32x32x16_bf16 v[48:63], v[68:71], v[112:115], v[48:63]
    ds_read_b64_tr_b16 v[92:93], v20 offset:6144
    ds_read_b64_tr_b16 v[94:95], v20 offset:7168
    v_mfma_f32_32x32x16_bf16 v[32:47], v[64:67], v[112:115], v[32:47]
    ds_read_b64_tr_b16 v[88:89], v8 offset:6144
    ds_read_b64_tr_b16 v[90:91], v8 offset:7168
    buffer_load_dwordx4 v[112:115], v16, s[12:15], s69 offen offset:2048 sc1
    s_waitcnt vmcnt(10) lgkmcnt(8)
    v_mfma_f32_32x32x16_bf16 v[48:63], v[76:79], v[116:119], v[48:63]
    ds_read_b64_tr_b16 v[68:69], v20 offset:16384
    ds_read_b64_tr_b16 v[70:71], v20 offset:17408
    v_mfma_f32_32x32x16_bf16 v[32:47], v[72:75], v[116:119], v[32:47]
    ds_read_b64_tr_b16 v[64:65], v8 offset:16384
    ds_read_b64_tr_b16 v[66:67], v8 offset:17408
    buffer_load_dwordx4 v[116:119], v16, s[12:15], s69 offen offset:3072 sc1
    s_waitcnt vmcnt(10) lgkmcnt(8)
    v_mfma_f32_32x32x16_bf16 v[48:63], v[84:87], v[120:123], v[48:63]
    ds_read_b64_tr_b16 v[76:77], v20 offset:18432
    ds_read_b64_tr_b16 v[78:79], v20 offset:19456
    v_mfma_f32_32x32x16_bf16 v[32:47], v[80:83], v[120:123], v[32:47]
    ds_read_b64_tr_b16 v[72:73], v8 offset:18432
    ds_read_b64_tr_b16 v[74:75], v8 offset:19456
K4_PS9:
    s_bitcmp1_b32 s66, 18
    s_cbranch_scc1 K4_QS9
    s_add_u32 s68, s68, 1
    s_cmp_gt_u32 s68, 131072
    s_cbranch_scc1 K4_QS9
    s_mov_b32 exec_lo, 0x1fffffff
    s_mov_b32 exec_hi, 0
    buffer_load_dword v24, v247, s[12:15], s65 offen sc1
    s_mov_b64 exec, -1
    s_waitcnt vmcnt(0)
    v_cmp_eq_u32 vcc, 1, v24
    s_and_b32 s66, s5, 1
    s_mov_b32 s67, vcc_lo
    s_lshr_b32 s66, s67, s66
    s_branch K4_PS9
K4_QS9:
    s_add_u32 s69, s61, 73728
    buffer_load_dwordx4 v[120:123], v16, s[12:15], s69 offen offset:0 sc1
    s_waitcnt vmcnt(10) lgkmcnt(8)
    v_mfma_f32_32x32x16_bf16 v[48:63], v[92:95], v[124:127], v[48:63]
    ds_read_b64_tr_b16 v[84:85], v20 offset:20480
    ds_read_b64_tr_b16 v[86:87], v20 offset:21504
    v_mfma_f32_32x32x16_bf16 v[32:47], v[88:91], v[124:127], v[32:47]
    ds_read_b64_tr_b16 v[80:81], v8 offset:20480
    ds_read_b64_tr_b16 v[82:83], v8 offset:21504
    buffer_load_dwordx4 v[124:127], v16, s[12:15], s69 offen offset:1024 sc1
    s_waitcnt vmcnt(10) lgkmcnt(8)
    v_mfma_f32_32x32x16_bf16 v[48:63], v[68:71], v[128:131], v[48:63]
    ds_read_b64_tr_b16 v[92:93], v20 offset:22528
    ds_read_b64_tr_b16 v[94:95], v20 offset:23552
    v_mfma_f32_32x32x16_bf16 v[32:47], v[64:67], v[128:131], v[32:47]
    ds_read_b64_tr_b16 v[88:89], v8 offset:22528
    ds_read_b64_tr_b16 v[90:91], v8 offset:23552
    buffer_load_dwordx4 v[128:131], v16, s[12:15], s69 offen offset:2048 sc1
    s_barrier
    s_waitcnt vmcnt(10) lgkmcnt(8)
    v_mfma_f32_32x32x16_bf16 v[48:63], v[76:79], v[132:135], v[48:63]
    ds_read_b64_tr_b16 v[68:69], v21 offset:0
    ds_read_b64_tr_b16 v[70:71], v21 offset:1024
    v_mfma_f32_32x32x16_bf16 v[32:47], v[72:75], v[132:135], v[32:47]
    ds_read_b64_tr_b16 v[64:65], v9 offset:0
    ds_read_b64_tr_b16 v[66:67], v9 offset:1024
    buffer_load_dwordx4 v[132:135], v16, s[12:15], s69 offen offset:3072 sc1
    s_waitcnt vmcnt(10) lgkmcnt(8)
    v_mfma_f32_32x32x16_bf16 v[48:63], v[84:87], v[96:99], v[48:63]
    ds_read_b64_tr_b16 v[76:77], v21 offset:2048
    ds_read_b64_tr_b16 v[78:79], v21 offset:3072
    v_mfma_f32_32x32x16_bf16 v[32:47], v[80:83], v[96:99], v[32:47]
    ds_read_b64_tr_b16 v[72:73], v9 offset:2048
    ds_read_b64_tr_b16 v[74:75], v9 offset:3072
K4_PS10:
    s_bitcmp1_b32 s66, 20
    s_cbranch_scc1 K4_QS10
    s_add_u32 s68, s68, 1
    s_cmp_gt_u32 s68, 131072
    s_cbranch_scc1 K4_QS10
    s_mov_b32 exec_lo, 0x1fffffff
    s_mov_b32 exec_hi, 0
    buffer_load_dword v24, v247, s[12:15], s65 offen sc1
    s_mov_b64 exec, -1
    s_waitcnt vmcnt(0)
    v_cmp_eq_u32 vcc, 1, v24
    s_and_b32 s66, s5, 1
    s_mov_b32 s67, vcc_lo
    s_lshr_b32 s66, s67, s66
    s_branch K4_PS10
K4_QS10:
    s_add_u32 s69, s61, 81920
    buffer_load_dwordx4 v[96:99], v16, s[12:15], s69 offen offset:0 sc1
    s_waitcnt vmcnt(10) lgkmcnt(8)
    v_mfma_f32_32x32x16_bf16 v[48:63], v[92:95], v[100:103], v[48:63]
    ds_read_b64_tr_b16 v[84:85], v21 offset:4096
    ds_read_b64_tr_b16 v[86:87], v21 offset:5120
    v_mfma_f32_32x32x16_bf16 v[32:47], v[88:91], v[100:103], v[32:47]
    ds_read_b64_tr_b16 v[80:81], v9 offset:4096
    ds_read_b64_tr_b16 v[82:83], v9 offset:5120
    buffer_load_dwordx4 v[100:103], v16, s[12:15], s69 offen offset:1024 sc1
    s_waitcnt vmcnt(9) lgkmcnt(8)
    v_mfma_f32_32x32x16_bf16 v[48:63], v[68:71], v[104:107], v[48:63]
    ds_read_b64_tr_b16 v[92:93], v21 offset:6144
    ds_read_b64_tr_b16 v[94:95], v21 offset:7168
    v_mfma_f32_32x32x16_bf16 v[32:47], v[64:67], v[104:107], v[32:47]
    ds_read_b64_tr_b16 v[88:89], v9 offset:6144
    ds_read_b64_tr_b16 v[90:91], v9 offset:7168
    buffer_load_dwordx4 v[104:107], v16, s[12:15], s69 offen offset:2048 sc1
    s_waitcnt vmcnt(9) lgkmcnt(8)
    v_mfma_f32_32x32x16_bf16 v[48:63], v[76:79], v[108:111], v[48:63]
    ds_read_b64_tr_b16 v[68:69], v20 offset:32768
    ds_read_b64_tr_b16 v[70:71], v20 offset:33792
    v_mfma_f32_32x32x16_bf16 v[32:47], v[72:75], v[108:111], v[32:47]
    ds_read_b64_tr_b16 v[64:65], v8 offset:32768
    ds_read_b64_tr_b16 v[66:67], v8 offset:33792
    buffer_load_dwordx4 v[108:111], v16, s[12:15], s69 offen offset:3072 sc1
    s_waitcnt vmcnt(9) lgkmcnt(8)
    v_mfma_f32_32x32x16_bf16 v[48:63], v[84:87], v[112:115], v[48:63]
    ds_read_b64_tr_b16 v[76:77], v20 offset:34816
    ds_read_b64_tr_b16 v[78:79], v20 offset:35840
    v_mfma_f32_32x32x16_bf16 v[32:47], v[80:83], v[112:115], v[32:47]
    ds_read_b64_tr_b16 v[72:73], v8 offset:34816
    ds_read_b64_tr_b16 v[74:75], v8 offset:35840
K4_PS11:
    s_bitcmp1_b32 s66, 22
    s_cbranch_scc1 K4_QS11
    s_add_u32 s68, s68, 1
    s_cmp_gt_u32 s68, 131072
    s_cbranch_scc1 K4_QS11
    s_mov_b32 exec_lo, 0x1fffffff
    s_mov_b32 exec_hi, 0
    buffer_load_dword v24, v247, s[12:15], s65 offen sc1
    s_mov_b64 exec, -1
    s_waitcnt vmcnt(0)
    v_cmp_eq_u32 vcc, 1, v24
    s_and_b32 s66, s5, 1
    s_mov_b32 s67, vcc_lo
    s_lshr_b32 s66, s67, s66
    s_branch K4_PS11
K4_QS11:
    s_add_u32 s69, s61, 90112
    buffer_load_dwordx4 v[112:115], v16, s[12:15], s69 offen offset:0 sc1
    s_waitcnt vmcnt(9) lgkmcnt(8)
    v_mfma_f32_32x32x16_bf16 v[48:63], v[92:95], v[116:119], v[48:63]
    ds_read_b64_tr_b16 v[84:85], v20 offset:36864
    ds_read_b64_tr_b16 v[86:87], v20 offset:37888
    v_mfma_f32_32x32x16_bf16 v[32:47], v[88:91], v[116:119], v[32:47]
    ds_read_b64_tr_b16 v[80:81], v8 offset:36864
    ds_read_b64_tr_b16 v[82:83], v8 offset:37888
    buffer_load_dwordx4 v[116:119], v16, s[12:15], s69 offen offset:1024 sc1
    s_waitcnt vmcnt(9) lgkmcnt(8)
    v_mfma_f32_32x32x16_bf16 v[48:63], v[68:71], v[120:123], v[48:63]
    ds_read_b64_tr_b16 v[92:93], v20 offset:38912
    ds_read_b64_tr_b16 v[94:95], v20 offset:39936
    v_mfma_f32_32x32x16_bf16 v[32:47], v[64:67], v[120:123], v[32:47]
    ds_read_b64_tr_b16 v[88:89], v8 offset:38912
    ds_read_b64_tr_b16 v[90:91], v8 offset:39936
    buffer_load_dwordx4 v[120:123], v16, s[12:15], s69 offen offset:2048 sc1
    s_barrier
    s_waitcnt vmcnt(9) lgkmcnt(8)
    v_mfma_f32_32x32x16_bf16 v[48:63], v[76:79], v[124:127], v[48:63]
    ds_read_b64_tr_b16 v[68:69], v21 offset:16384
    ds_read_b64_tr_b16 v[70:71], v21 offset:17408
    v_mfma_f32_32x32x16_bf16 v[32:47], v[72:75], v[124:127], v[32:47]
    ds_read_b64_tr_b16 v[64:65], v9 offset:16384
    ds_read_b64_tr_b16 v[66:67], v9 offset:17408
    buffer_load_dwordx4 v[124:127], v16, s[12:15], s69 offen offset:3072 sc1
    s_waitcnt vmcnt(9) lgkmcnt(8)
    v_mfma_f32_32x32x16_bf16 v[48:63], v[84:87], v[128:131], v[48:63]
    ds_read_b64_tr_b16 v[76:77], v21 offset:18432
    ds_read_b64_tr_b16 v[78:79], v21 offset:19456
    v_mfma_f32_32x32x16_bf16 v[32:47], v[80:83], v[128:131], v[32:47]
    ds_read_b64_tr_b16 v[72:73], v9 offset:18432
    ds_read_b64_tr_b16 v[74:75], v9 offset:19456
K4_PS12:
    s_bitcmp1_b32 s66, 24
    s_cbranch_scc1 K4_QS12
    s_add_u32 s68, s68, 1
    s_cmp_gt_u32 s68, 131072
    s_cbranch_scc1 K4_QS12
    s_mov_b32 exec_lo, 0x1fffffff
    s_mov_b32 exec_hi, 0
    buffer_load_dword v24, v247, s[12:15], s65 offen sc1
    s_mov_b64 exec, -1
    s_waitcnt vmcnt(0)
    v_cmp_eq_u32 vcc, 1, v24
    s_and_b32 s66, s5, 1
    s_mov_b32 s67, vcc_lo
    s_lshr_b32 s66, s67, s66
    s_branch K4_PS12
K4_QS12:
    s_add_u32 s69, s61, 98304
    buffer_load_dwordx4 v[128:131], v16, s[12:15], s69 offen offset:0 sc1
    s_waitcnt vmcnt(9) lgkmcnt(8)
    v_mfma_f32_32x32x16_bf16 v[48:63], v[92:95], v[132:135], v[48:63]
    ds_read_b64_tr_b16 v[84:85], v21 offset:20480
    ds_read_b64_tr_b16 v[86:87], v21 offset:21504
    v_mfma_f32_32x32x16_bf16 v[32:47], v[88:91], v[132:135], v[32:47]
    ds_read_b64_tr_b16 v[80:81], v9 offset:20480
    ds_read_b64_tr_b16 v[82:83], v9 offset:21504
    buffer_load_dwordx4 v[132:135], v16, s[12:15], s69 offen offset:1024 sc1
    s_waitcnt vmcnt(9) lgkmcnt(8)
    v_mfma_f32_32x32x16_bf16 v[48:63], v[68:71], v[96:99], v[48:63]
    ds_read_b64_tr_b16 v[92:93], v21 offset:22528
    ds_read_b64_tr_b16 v[94:95], v21 offset:23552
    v_mfma_f32_32x32x16_bf16 v[32:47], v[64:67], v[96:99], v[32:47]
    ds_read_b64_tr_b16 v[88:89], v9 offset:22528
    ds_read_b64_tr_b16 v[90:91], v9 offset:23552
    buffer_load_dwordx4 v[96:99], v16, s[12:15], s69 offen offset:2048 sc1
    s_waitcnt vmcnt(9) lgkmcnt(8)
    v_mfma_f32_32x32x16_bf16 v[48:63], v[76:79], v[100:103], v[48:63]
    ds_read_b64_tr_b16 v[68:69], v21 offset:32768
    ds_read_b64_tr_b16 v[70:71], v21 offset:33792
    v_mfma_f32_32x32x16_bf16 v[32:47], v[72:75], v[100:103], v[32:47]
    ds_read_b64_tr_b16 v[64:65], v9 offset:32768
    ds_read_b64_tr_b16 v[66:67], v9 offset:33792
    buffer_load_dwordx4 v[100:103], v16, s[12:15], s69 offen offset:3072 sc1
    s_waitcnt vmcnt(9) lgkmcnt(8)
    v_mfma_f32_32x32x16_bf16 v[48:63], v[84:87], v[104:107], v[48:63]
    ds_read_b64_tr_b16 v[76:77], v21 offset:34816
    ds_read_b64_tr_b16 v[78:79], v21 offset:35840
    v_mfma_f32_32x32x16_bf16 v[32:47], v[80:83], v[104:107], v[32:47]
    ds_read_b64_tr_b16 v[72:73], v9 offset:34816
    ds_read_b64_tr_b16 v[74:75], v9 offset:35840
K4_PS13:
    s_bitcmp1_b32 s66, 26
    s_cbranch_scc1 K4_QS13
    s_add_u32 s68, s68, 1
    s_cmp_gt_u32 s68, 131072
    s_cbranch_scc1 K4_QS13
    s_mov_b32 exec_lo, 0x1fffffff
    s_mov_b32 exec_hi, 0
    buffer_load_dword v24, v247, s[12:15], s65 offen sc1
    s_mov_b64 exec, -1
    s_waitcnt vmcnt(0)
    v_cmp_eq_u32 vcc, 1, v24
    s_and_b32 s66, s5, 1
    s_mov_b32 s67, vcc_lo
    s_lshr_b32 s66, s67, s66
    s_branch K4_PS13
K4_QS13:
    s_add_u32 s69, s61, 106496
    buffer_load_dwordx4 v[104:107], v16, s[12:15], s69 offen offset:0 sc1
    s_waitcnt vmcnt(9) lgkmcnt(8)
    v_mfma_f32_32x32x16_bf16 v[48:63], v[92:95], v[108:111], v[48:63]
    ds_read_b64_tr_b16 v[84:85], v21 offset:36864
    ds_read_b64_tr_b16 v[86:87], v21 offset:37888
    v_mfma_f32_32x32x16_bf16 v[32:47], v[88:91], v[108:111], v[32:47]
    ds_read_b64_tr_b16 v[80:81], v9 offset:36864
    ds_read_b64_tr_b16 v[82:83], v9 offset:37888
    buffer_load_dwordx4 v[108:111], v16, s[12:15], s69 offen offset:1024 sc1
    s_waitcnt vmcnt(9) lgkmcnt(8)
    v_mfma_f32_32x32x16_bf16 v[48:63], v[68:71], v[112:115], v[48:63]
    ds_read_b64_tr_b16 v[92:93], v21 offset:38912
    ds_read_b64_tr_b16 v[94:95], v21 offset:39936
    v_mfma_f32_32x32x16_bf16 v[32:47], v[64:67], v[112:115], v[32:47]
    ds_read_b64_tr_b16 v[88:89], v9 offset:38912
    ds_read_b64_tr_b16 v[90:91], v9 offset:39936
    buffer_load_dwordx4 v[112:115], v16, s[12:15], s69 offen offset:2048 sc1
    s_barrier
    s_waitcnt vmcnt(9) lgkmcnt(8)
    v_mfma_f32_32x32x16_bf16 v[48:63], v[76:79], v[116:119], v[48:63]
    ds_read_b64_tr_b16 v[68:69], v20 offset:49152
    ds_read_b64_tr_b16 v[70:71], v20 offset:50176
    v_mfma_f32_32x32x16_bf16 v[32:47], v[72:75], v[116:119], v[32:47]
    ds_read_b64_tr_b16 v[64:65], v8 offset:49152
    ds_read_b64_tr_b16 v[66:67], v8 offset:50176
    buffer_load_dwordx4 v[116:119], v16, s[12:15], s69 offen offset:3072 sc1
    s_waitcnt vmcnt(9) lgkmcnt(8)
    v_mfma_f32_32x32x16_bf16 v[48:63], v[84:87], v[120:123], v[48:63]
    ds_read_b64_tr_b16 v[76:77], v20 offset:51200
    ds_read_b64_tr_b16 v[78:79], v20 offset:52224
    v_mfma_f32_32x32x16_bf16 v[32:47], v[80:83], v[120:123], v[32:47]
    ds_read_b64_tr_b16 v[72:73], v8 offset:51200
    ds_read_b64_tr_b16 v[74:75], v8 offset:52224
    s_waitcnt vmcnt(8) lgkmcnt(8)
    v_mfma_f32_32x32x16_bf16 v[48:63], v[92:95], v[124:127], v[48:63]
    ds_read_b64_tr_b16 v[84:85], v20 offset:53248
    ds_read_b64_tr_b16 v[86:87], v20 offset:54272
    v_mfma_f32_32x32x16_bf16 v[32:47], v[88:91], v[124:127], v[32:47]
    ds_read_b64_tr_b16 v[80:81], v8 offset:53248
    ds_read_b64_tr_b16 v[82:83], v8 offset:54272
    s_waitcnt vmcnt(7) lgkmcnt(8)
    v_mfma_f32_32x32x16_bf16 v[48:63], v[68:71], v[128:131], v[48:63]
    ds_read_b64_tr_b16 v[92:93], v20 offset:55296
    ds_read_b64_tr_b16 v[94:95], v20 offset:56320
    v_mfma_f32_32x32x16_bf16 v[32:47], v[64:67], v[128:131], v[32:47]
    ds_read_b64_tr_b16 v[88:89], v8 offset:55296
    ds_read_b64_tr_b16 v[90:91], v8 offset:56320
    s_waitcnt vmcnt(6) lgkmcnt(8)
    v_mfma_f32_32x32x16_bf16 v[48:63], v[76:79], v[132:135], v[48:63]
    ds_read_b64_tr_b16 v[68:69], v21 offset:49152
    ds_read_b64_tr_b16 v[70:71], v21 offset:50176
    v_mfma_f32_32x32x16_bf16 v[32:47], v[72:75], v[132:135], v[32:47]
    ds_read_b64_tr_b16 v[64:65], v9 offset:49152
    ds_read_b64_tr_b16 v[66:67], v9 offset:50176
    s_waitcnt vmcnt(5) lgkmcnt(8)
    v_mfma_f32_32x32x16_bf16 v[48:63], v[84:87], v[96:99], v[48:63]
    ds_read_b64_tr_b16 v[76:77], v21 offset:51200
    ds_read_b64_tr_b16 v[78:79], v21 offset:52224
    v_mfma_f32_32x32x16_bf16 v[32:47], v[80:83], v[96:99], v[32:47]
    ds_read_b64_tr_b16 v[72:73], v9 offset:51200
    ds_read_b64_tr_b16 v[74:75], v9 offset:52224
    s_waitcnt vmcnt(4) lgkmcnt(8)
    v_mfma_f32_32x32x16_bf16 v[48:63], v[92:95], v[100:103], v[48:63]
    ds_read_b64_tr_b16 v[84:85], v21 offset:53248
    ds_read_b64_tr_b16 v[86:87], v21 offset:54272
    v_mfma_f32_32x32x16_bf16 v[32:47], v[88:91], v[100:103], v[32:47]
    ds_read_b64_tr_b16 v[80:81], v9 offset:53248
    ds_read_b64_tr_b16 v[82:83], v9 offset:54272
    s_waitcnt vmcnt(3) lgkmcnt(8)
    v_mfma_f32_32x32x16_bf16 v[48:63], v[68:71], v[104:107], v[48:63]
    ds_read_b64_tr_b16 v[92:93], v21 offset:55296
    ds_read_b64_tr_b16 v[94:95], v21 offset:56320
    v_mfma_f32_32x32x16_bf16 v[32:47], v[64:67], v[104:107], v[32:47]
    ds_read_b64_tr_b16 v[88:89], v9 offset:55296
    ds_read_b64_tr_b16 v[90:91], v9 offset:56320
    s_waitcnt vmcnt(2) lgkmcnt(8)
    v_mfma_f32_32x32x16_bf16 v[48:63], v[76:79], v[108:111], v[48:63]
    ds_read_b64_tr_b16 v[136:137], v12 offset:0
    ds_read_b64_tr_b16 v[138:139], v12 offset:512
    v_mfma_f32_32x32x16_bf16 v[32:47], v[72:75], v[108:111], v[32:47]
    ds_read_b64_tr_b16 v[140:141], v12 offset:2048
    ds_read_b64_tr_b16 v[142:143], v12 offset:2560
    s_waitcnt vmcnt(1) lgkmcnt(8)
    v_mfma_f32_32x32x16_bf16 v[48:63], v[84:87], v[112:115], v[48:63]
    v_mfma_f32_32x32x16_bf16 v[32:47], v[80:83], v[112:115], v[32:47]
    s_waitcnt vmcnt(0) lgkmcnt(4)
    v_mfma_f32_32x32x16_bf16 v[48:63], v[92:95], v[116:119], v[48:63]
    v_mfma_f32_32x32x16_bf16 v[32:47], v[88:91], v[116:119], v[32:47]
    s_waitcnt lgkmcnt(0)
    v_lshlrev_b32 v144, 16, v136
    v_and_b32 v145, 0xffff0000, v136
    v_lshlrev_b32 v146, 16, v137
    v_and_b32 v147, 0xffff0000, v137
    v_lshlrev_b32 v148, 16, v138
    v_and_b32 v149, 0xffff0000, v138
    v_lshlrev_b32 v150, 16, v139
    v_and_b32 v151, 0xffff0000, v139
    s_nop 3
    ds_write_b128 v15, v[48:51] offset:0
    ds_write_b128 v15, v[52:55] offset:1024
    ds_write_b128 v15, v[56:59] offset:2048
    ds_write_b128 v15, v[60:63] offset:3072
    v_lshlrev_b32 v152, 16, v140
    v_and_b32 v153, 0xffff0000, v140
    v_lshlrev_b32 v154, 16, v141
    v_and_b32 v155, 0xffff0000, v141
    v_lshlrev_b32 v156, 16, v142
    v_and_b32 v157, 0xffff0000, v142
    v_lshlrev_b32 v158, 16, v143
    v_and_b32 v159, 0xffff0000, v143
    s_waitcnt vmcnt(0) lgkmcnt(0)
    s_barrier
    ds_read_b128 v[160:163], v17 offset:0
    ds_read_b128 v[164:167], v17 offset:1024
    ds_read_b128 v[168:171], v17 offset:2048
    ds_read_b128 v[172:175], v17 offset:3072
    v_pk_mul_f32 v[32:33], v[32:33], v[18:19] op_sel_hi:[1,0]
    v_pk_mul_f32 v[34:35], v[34:35], v[18:19] op_sel_hi:[1,0]
    v_pk_mul_f32 v[36:37], v[36:37], v[18:19] op_sel_hi:[1,0]
    v_pk_mul_f32 v[38:39], v[38:39], v[18:19] op_sel_hi:[1,0]
    v_pk_mul_f32 v[40:41], v[40:41], v[18:19] op_sel_hi:[1,0]
    v_pk_mul_f32 v[42:43], v[42:43], v[18:19] op_sel_hi:[1,0]
    v_pk_mul_f32 v[44:45], v[44:45], v[18:19] op_sel_hi:[1,0]
    v_pk_mul_f32 v[46:47], v[46:47], v[18:19] op_sel_hi:[1,0]
    s_waitcnt lgkmcnt(3)
    v_pk_fma_f32 v[32:33], v[160:161], v[18:19], v[32:33] op_sel_hi:[1,0,1]
    v_pk_fma_f32 v[34:35], v[162:163], v[18:19], v[34:35] op_sel_hi:[1,0,1]
    s_waitcnt lgkmcnt(2)
    v_pk_fma_f32 v[36:37], v[164:165], v[18:19], v[36:37] op_sel_hi:[1,0,1]
    v_pk_fma_f32 v[38:39], v[166:167], v[18:19], v[38:39] op_sel_hi:[1,0,1]
    v_cvt_pk_bf16_f32 v136, v32, v33
    v_cvt_pk_bf16_f32 v137, v34, v35
    v_cvt_pk_bf16_f32 v138, v36, v37
    v_cvt_pk_bf16_f32 v139, v38, v39
    v_lshlrev_b32 v32, 16, v136
    v_and_b32 v33, 0xffff0000, v136
    v_lshlrev_b32 v34, 16, v137
    v_and_b32 v35, 0xffff0000, v137
    v_lshlrev_b32 v36, 16, v138
    v_and_b32 v37, 0xffff0000, v138
    v_lshlrev_b32 v38, 16, v139
    v_and_b32 v39, 0xffff0000, v139
    v_pk_add_f32 v[32:33], v[32:33], v[144:145]
    v_pk_add_f32 v[34:35], v[34:35], v[146:147]
    v_pk_add_f32 v[36:37], v[36:37], v[148:149]
    v_pk_add_f32 v[38:39], v[38:39], v[150:151]
    v_cvt_pk_bf16_f32 v32, v32, v33
    v_cvt_pk_bf16_f32 v33, v34, v35
    v_cvt_pk_bf16_f32 v34, v36, v37
    v_cvt_pk_bf16_f32 v35, v38, v39
    ds_write_b128 v14, v[32:35] offset:0
    s_waitcnt lgkmcnt(2)
    v_pk_fma_f32 v[40:41], v[168:169], v[18:19], v[40:41] op_sel_hi:[1,0,1]
    v_pk_fma_f32 v[42:43], v[170:171], v[18:19], v[42:43] op_sel_hi:[1,0,1]
    s_waitcnt lgkmcnt(1)
    v_pk_fma_f32 v[44:45], v[172:173], v[18:19], v[44:45] op_sel_hi:[1,0,1]
    v_pk_fma_f32 v[46:47], v[174:175], v[18:19], v[46:47] op_sel_hi:[1,0,1]
    v_cvt_pk_bf16_f32 v136, v40, v41
    v_cvt_pk_bf16_f32 v137, v42, v43
    v_cvt_pk_bf16_f32 v138, v44, v45
    v_cvt_pk_bf16_f32 v139, v46, v47
    v_lshlrev_b32 v40, 16, v136
    v_and_b32 v41, 0xffff0000, v136
    v_lshlrev_b32 v42, 16, v137
    v_and_b32 v43, 0xffff0000, v137
    v_lshlrev_b32 v44, 16, v138
    v_and_b32 v45, 0xffff0000, v138
    v_lshlrev_b32 v46, 16, v139
    v_and_b32 v47, 0xffff0000, v139
    v_pk_add_f32 v[40:41], v[40:41], v[152:153]
    v_pk_add_f32 v[42:43], v[42:43], v[154:155]
    v_pk_add_f32 v[44:45], v[44:45], v[156:157]
    v_pk_add_f32 v[46:47], v[46:47], v[158:159]
    v_cvt_pk_bf16_f32 v40, v40, v41
    v_cvt_pk_bf16_f32 v41, v42, v43
    v_cvt_pk_bf16_f32 v42, v44, v45
    v_cvt_pk_bf16_f32 v43, v46, v47
    ds_write_b128 v19, v[40:43] offset:1024
    ds_read_b128 v[36:39], v25
    ds_read_b128 v[44:47], v23
    s_waitcnt lgkmcnt(1)
    buffer_store_dwordx4 v[36:39], v6, s[56:59], s47 offen sc1
    s_waitcnt lgkmcnt(0)
    buffer_store_dwordx4 v[44:47], v6, s[56:59], s47 offen offset:1024 sc1
K4_END:
    s_endpgm
K4_R0:
    s_add_u32 s68, s68, 1
    s_cmp_gt_u32 s68, 131072
    s_cbranch_scc1 K4_D0
    s_add_u32 s70, s62, 0
    buffer_load_dwordx4 v[96:99], v16, s[12:15], s70 offen offset:0 sc1
    buffer_load_dwordx4 v[100:103], v16, s[12:15], s70 offen offset:1024 sc1
    buffer_load_dwordx4 v[104:107], v16, s[12:15], s70 offen offset:2048 sc1
    buffer_load_dwordx4 v[108:111], v16, s[12:15], s70 offen offset:3072 sc1
    s_waitcnt vmcnt(0)
    v_cmp_gt_i32 vcc, 0, v98
    s_nop 0
    s_cbranch_vccnz K4_R0
    s_branch K4_D0
K4_R1:
    s_add_u32 s68, s68, 1
    s_cmp_gt_u32 s68, 131072
    s_cbranch_scc1 K4_D1
    s_add_u32 s70, s62, 0
    buffer_load_dwordx4 v[100:103], v16, s[12:15], s70 offen offset:1024 sc1
    buffer_load_dwordx4 v[104:107], v16, s[12:15], s70 offen offset:2048 sc1
    buffer_load_dwordx4 v[108:111], v16, s[12:15], s70 offen offset:3072 sc1
    s_waitcnt vmcnt(0)
    v_cmp_gt_i32 vcc, 0, v102
    s_nop 0
    s_cbranch_vccnz K4_R1
    s_branch K4_D1
K4_R2:
    s_add_u32 s68, s68, 1
    s_cmp_gt_u32 s68, 131072
    s_cbranch_scc1 K4_D2
    s_add_u32 s70, s62, 0
    buffer_load_dwordx4 v[104:107], v16, s[12:15], s70 offen offset:2048 sc1
    buffer_load_dwordx4 v[108:111], v16, s[12:15], s70 offen offset:3072 sc1
    s_waitcnt vmcnt(0)
    v_cmp_gt_i32 vcc, 0, v106
    s_nop 0
    s_cbranch_vccnz K4_R2
    s_branch K4_D2
K4_R3:
    s_add_u32 s68, s68, 1
    s_cmp_gt_u32 s68, 131072
    s_cbranch_scc1 K4_D3
    s_add_u32 s70, s62, 0
    buffer_load_dwordx4 v[108:111], v16, s[12:15], s70 offen offset:3072 sc1
    s_waitcnt vmcnt(0)
    v_cmp_gt_i32 vcc, 0, v110
    s_nop 0
    s_cbranch_vccnz K4_R3
    s_branch K4_D3
K4_R4:
    s_add_u32 s68, s68, 1
    s_cmp_gt_u32 s68, 131072
    s_cbranch_scc1 K4_D4
    s_add_u32 s70, s62, 8192
    buffer_load_dwordx4 v[112:115], v16, s[12:15], s70 offen offset:0 sc1
    buffer_load_dwordx4 v[116:119], v16, s[12:15], s70 offen offset:1024 sc1
    buffer_load_dwordx4 v[120:123], v16, s[12:15], s70 offen offset:2048 sc1
    buffer_load_dwordx4 v[124:127], v16, s[12:15], s70 offen offset:3072 sc1
    s_waitcnt vmcnt(0)
    v_cmp_gt_i32 vcc, 0, v114
    s_nop 0
    s_cbranch_vccnz K4_R4
    s_branch K4_D4
K4_R5:
    s_add_u32 s68, s68, 1
    s_cmp_gt_u32 s68, 131072
    s_cbranch_scc1 K4_D5
    s_add_u32 s70, s62, 8192
    buffer_load_dwordx4 v[116:119], v16, s[12:15], s70 offen offset:1024 sc1
    buffer_load_dwordx4 v[120:123], v16, s[12:15], s70 offen offset:2048 sc1
    buffer_load_dwordx4 v[124:127], v16, s[12:15], s70 offen offset:3072 sc1
    s_waitcnt vmcnt(0)
    v_cmp_gt_i32 vcc, 0, v118
    s_nop 0
    s_cbranch_vccnz K4_R5
    s_branch K4_D5
K4_R6:
    s_add_u32 s68, s68, 1
    s_cmp_gt_u32 s68, 131072
    s_cbranch_scc1 K4_D6
    s_add_u32 s70, s62, 8192
    buffer_load_dwordx4 v[120:123], v16, s[12:15], s70 offen offset:2048 sc1
    buffer_load_dwordx4 v[124:127], v16, s[12:15], s70 offen offset:3072 sc1
    s_waitcnt vmcnt(0)
    v_cmp_gt_i32 vcc, 0, v122
    s_nop 0
    s_cbranch_vccnz K4_R6
    s_branch K4_D6
K4_R7:
    s_add_u32 s68, s68, 1
    s_cmp_gt_u32 s68, 131072
    s_cbranch_scc1 K4_D7
    s_add_u32 s70, s62, 8192
    buffer_load_dwordx4 v[124:127], v16, s[12:15], s70 offen offset:3072 sc1
    s_waitcnt vmcnt(0)
    v_cmp_gt_i32 vcc, 0, v126
    s_nop 0
    s_cbranch_vccnz K4_R7
    s_branch K4_D7
K4_R8:
    s_add_u32 s68, s68, 1
    s_cmp_gt_u32 s68, 131072
    s_cbranch_scc1 K4_D8
    s_add_u32 s70, s62, 16512
    buffer_load_dwordx4 v[128:131], v16, s[12:15], s70 offen offset:0 sc1
    buffer_load_dwordx4 v[132:135], v16, s[12:15], s70 offen offset:1024 sc1
    buffer_load_dwordx4 v[96:99], v16, s[12:15], s70 offen offset:2048 sc1
    buffer_load_dwordx4 v[100:103], v16, s[12:15], s70 offen offset:3072 sc1
    s_waitcnt vmcnt(0)
    v_cmp_gt_i32 vcc, 0, v130
    s_nop 0
    s_cbranch_vccnz K4_R8
    s_branch K4_D8
K4_R9:
    s_add_u32 s68, s68, 1
    s_cmp_gt_u32 s68, 131072
    s_cbranch_scc1 K4_D9
    s_add_u32 s70, s62, 16512
    buffer_load_dwordx4 v[132:135], v16, s[12:15], s70 offen offset:1024 sc1
    buffer_load_dwordx4 v[96:99], v16, s[12:15], s70 offen offset:2048 sc1
    buffer_load_dwordx4 v[100:103], v16, s[12:15], s70 offen offset:3072 sc1
    s_waitcnt vmcnt(0)
    v_cmp_gt_i32 vcc, 0, v134
    s_nop 0
    s_cbranch_vccnz K4_R9
    s_branch K4_D9
K4_R10:
    s_add_u32 s68, s68, 1
    s_cmp_gt_u32 s68, 131072
    s_cbranch_scc1 K4_D10
    s_add_u32 s70, s62, 16512
    buffer_load_dwordx4 v[96:99], v16, s[12:15], s70 offen offset:2048 sc1
    buffer_load_dwordx4 v[100:103], v16, s[12:15], s70 offen offset:3072 sc1
    s_waitcnt vmcnt(0)
    v_cmp_gt_i32 vcc, 0, v98
    s_nop 0
    s_cbranch_vccnz K4_R10
    s_branch K4_D10
K4_R11:
    s_add_u32 s68, s68, 1
    s_cmp_gt_u32 s68, 131072
    s_cbranch_scc1 K4_D11
    s_add_u32 s70, s62, 16512
    buffer_load_dwordx4 v[100:103], v16, s[12:15], s70 offen offset:3072 sc1
    s_waitcnt vmcnt(0)
    v_cmp_gt_i32 vcc, 0, v102
    s_nop 0
    s_cbranch_vccnz K4_R11
    s_branch K4_D11
K4_R12:
    s_add_u32 s68, s68, 1
    s_cmp_gt_u32 s68, 131072
    s_cbranch_scc1 K4_D12
    s_add_u32 s70, s62, 24704
    buffer_load_dwordx4 v[104:107], v16, s[12:15], s70 offen offset:0 sc1
    buffer_load_dwordx4 v[108:111], v16, s[12:15], s70 offen offset:1024 sc1
    buffer_load_dwordx4 v[112:115], v16, s[12:15], s70 offen offset:2048 sc1
    buffer_load_dwordx4 v[116:119], v16, s[12:15], s70 offen offset:3072 sc1
    s_waitcnt vmcnt(0)
    v_cmp_gt_i32 vcc, 0, v106
    s_nop 0
    s_cbranch_vccnz K4_R12
    s_branch K4_D12
K4_R13:
    s_add_u32 s68, s68, 1
    s_cmp_gt_u32 s68, 131072
    s_cbranch_scc1 K4_D13
    s_add_u32 s70, s62, 24704
    buffer_load_dwordx4 v[108:111], v16, s[12:15], s70 offen offset:1024 sc1
    buffer_load_dwordx4 v[112:115], v16, s[12:15], s70 offen offset:2048 sc1
    buffer_load_dwordx4 v[116:119], v16, s[12:15], s70 offen offset:3072 sc1
    s_waitcnt vmcnt(0)
    v_cmp_gt_i32 vcc, 0, v110
    s_nop 0
    s_cbranch_vccnz K4_R13
    s_branch K4_D13
K4_R14:
    s_add_u32 s68, s68, 1
    s_cmp_gt_u32 s68, 131072
    s_cbranch_scc1 K4_D14
    s_add_u32 s70, s62, 24704
    buffer_load_dwordx4 v[112:115], v16, s[12:15], s70 offen offset:2048 sc1
    buffer_load_dwordx4 v[116:119], v16, s[12:15], s70 offen offset:3072 sc1
    s_waitcnt vmcnt(0)
    v_cmp_gt_i32 vcc, 0, v114
    s_nop 0
    s_cbranch_vccnz K4_R14
    s_branch K4_D14
K4_R15:
    s_add_u32 s68, s68, 1
    s_cmp_gt_u32 s68, 131072
    s_cbranch_scc1 K4_D15
    s_add_u32 s70, s62, 24704
    buffer_load_dwordx4 v[116:119], v16, s[12:15], s70 offen offset:3072 sc1
    s_waitcnt vmcnt(0)
    v_cmp_gt_i32 vcc, 0, v118
    s_nop 0
    s_cbranch_vccnz K4_R15
    s_branch K4_D15
CODE_END:
.section .rodata,"a"
.p2align 6
.amdhsa_kernel sequential_preLN__ssm_conv_s4d__dense_activation_relu__prompt_kernel
  .amdhsa_next_free_vgpr 256
  .amdhsa_next_free_sgpr 102
  .amdhsa_accum_offset 256
  .amdhsa_group_segment_fixed_size 0
  .amdhsa_kernarg_size 104
  .amdhsa_user_sgpr_count 2
  .amdhsa_user_sgpr_kernarg_segment_ptr 1
  .amdhsa_system_sgpr_workgroup_id_x 1
.end_amdhsa_kernel
```
